```python
import torch

def _softmax(x, axis=-1):
    return torch.softmax(x, dim=axis)
def _gelu(x):
    return torch.nn.functional.gelu(x, approximate="tanh")
def _silu(x):
    return torch.nn.functional.silu(x)
def _sigmoid(x):
    return torch.sigmoid(x)
def _layernorm(x, axis=-1, eps=1e-5):
    m = x.mean(dim=axis, keepdim=True)
    v = x.var(dim=axis, keepdim=True, unbiased=False)
    return (x - m) / torch.sqrt(v + eps)
def _scatter_add(tgt, idx, src, axis=0):
    return tgt.clone().index_add_(axis, idx, src)
def _segment_sum(src, seg, n):
    out = torch.zeros((n,) + src.shape[1:], dtype=src.dtype)
    return out.index_add_(0, seg, src)
def _pad(x, pw):
    flat = tuple(v for pair in reversed(pw) for v in pair)
    return torch.nn.functional.pad(x, flat)

kernel_name = 'gated_mix__compressed_kv_cla__swiglu_ffn__decode'

def setup_inputs():

    _w = (lambda a: (lambda t: t.to(torch.bfloat16) if t.is_floating_point() else t)(torch.as_tensor(a)))
    def _A_setup():
        B, H, Sq, Sk, D, M = 4, 32, 1, 4096, 128, 512
        Dc = 4 * D
        return {
            "x": _w((lambda *s: torch.randn(*s, dtype=torch.bfloat16) * 0.05)(B, Sq, M)),
            "c_kv": _w((lambda *s: torch.randn(*s, dtype=torch.bfloat16) * 0.8)(B, Sk, Dc)),
            "w_q": _w((lambda *s: torch.randn(*s, dtype=torch.bfloat16) * 6.4)(M, H, D) * (M ** -0.5)),
            "w_uk": _w((lambda *s: torch.randn(*s, dtype=torch.bfloat16) * 6.4)(Dc, H, D) * (Dc ** -0.5)),
            "w_uv": _w((lambda *s: torch.randn(*s, dtype=torch.bfloat16) * 0.8)(Dc, H, D) * (Dc ** -0.5)),
            "w_o": _w((lambda *s: torch.randn(*s, dtype=torch.bfloat16) * 0.8)(H, D, M) * ((H * D) ** -0.5)),
        }
    _A_in = _A_setup()

    def _B_setup():
        B, S, D, F = 4, 1, 512, 1792
        return {
            "x": _w((lambda *s: torch.randn(*s, dtype=torch.bfloat16) * 0.05)(B, S, D)),
            "w_gate": _w((lambda *s: torch.randn(*s, dtype=torch.bfloat16) * 0.1)(D, F)),
            "w_up": _w((lambda *s: torch.randn(*s, dtype=torch.bfloat16) * 0.1)(D, F)),
            "w_down": _w((lambda *s: torch.randn(*s, dtype=torch.bfloat16) * 0.1)(F, D)),
        }
    _B_in = _B_setup()

    return {
        "A_x": _A_in["x"],
        "A_c_kv": _A_in["c_kv"],
        "A_w_q": _A_in["w_q"],
        "A_w_uk": _A_in["w_uk"],
        "A_w_uv": _A_in["w_uv"],
        "A_w_o": _A_in["w_o"],
        "B_x": _B_in["x"],
        "B_w_gate": _B_in["w_gate"],
        "B_w_up": _B_in["w_up"],
        "B_w_down": _B_in["w_down"],
        "gate_w": _w((lambda *s: torch.randn(*s, dtype=torch.bfloat16) * 0.05)(512) * 16.0),
    }

def reference(A_x, A_c_kv, A_w_q, A_w_uk, A_w_uv, A_w_o, B_x, B_w_gate, B_w_up, B_w_down, gate_w):
    def _A_ref(x, c_kv, w_q, w_uk, w_uv, w_o):
        B, Sq, M = x.shape[0], x.shape[1], x.shape[2]
        Sk = c_kv.shape[1]
        H, D = w_q.shape[1], w_q.shape[2]
        q = torch.einsum("bqm,mhd->bhqd", x, w_q)
        k = torch.einsum("bkc,chd->bhkd", c_kv, w_uk)
        v = torch.einsum("bkc,chd->bhkd", c_kv, w_uv)
        scores = torch.einsum("bhqd,bhkd->bhqk", q, k) * (D ** -0.5)
        off = Sk - Sq
        qi = torch.arange(Sq)[:, None]
        kj = torch.arange(Sk)[None, :]
        cmask = kj <= (qi + off)
        scores = torch.where(cmask[None, None], scores, -1e9)
        p = _softmax(scores, axis=-1)
        ctx = torch.einsum("bhqk,bhkd->bhqd", p, v)
        return torch.einsum("bhqd,hdm->bqm", ctx, w_o)

    def _B_ref(x, w_gate, w_up, w_down):
        g = _silu(x @ w_gate)
        u = x @ w_up
        return (g * u) @ w_down

    x = A_x
    g = _sigmoid((x * gate_w).sum(-1, keepdims=True))
    a = _A_ref(x, A_c_kv, A_w_q, A_w_uk, A_w_uv, A_w_o)
    b = _B_ref(x, B_w_gate, B_w_up, B_w_down)
    return g * a + (1 - g) * b
```

```asm
; @launch grid=(256,1,1) block=(256,1,1) lds=146688
.amdgcn_target "amdgcn-amd-amdhsa--gfx950"
.text
.globl gated_mix__compressed_kv_cla__swiglu_ffn__decode_kernel
.p2align 8
.type gated_mix__compressed_kv_cla__swiglu_ffn__decode_kernel,@function
gated_mix__compressed_kv_cla__swiglu_ffn__decode_kernel:
    s_load_dwordx16 s[4:19], s[0:1], 0
    s_load_dwordx4 s[28:31], s[0:1], 96
    s_cmp_ge_u32 s2, 256
    s_cbranch_scc1 L_end
    v_lshrrev_b32 v1, 6, v0
    v_and_b32 v2, 63, v0
    v_readfirstlane_b32 s32, v1
    v_lshrrev_b32 v3, 4, v2
    v_and_b32 v4, 15, v2
    s_and_b32 s33, s2, 7
    s_bfe_u32 s36, s2, 0x20003
    s_lshr_b32 s37, s2, 6
    s_lshl2_add_u32 s34, s37, s36
    s_bitcmp1_b32 s2, 5
    s_cbranch_scc1 L_at0
    s_lshl2_add_u32 s38, s33, s36
    s_lshl_b32 s39, s38, 8
    s_lshl_b32 s40, s37, 20
    s_add_u32 s39, s39, s40
    v_and_b32 v13, 1, v3
    v_lshlrev_b32 v13, 3, v13
    v_xor_b32 v13, v13, v4
    v_lshrrev_b32 v6, 4, v0
    v_lshlrev_b32 v7, 16, v6
    v_lshl_add_u32 v7, v13, 4, v7
    v_add_u32 v7, s39, v7
    v_xor_b32 v8, 512, v7
    s_mul_i32 s41, s32, 8448
    v_bfe_u32 v9, v2, 2, 2
    v_lshlrev_b32 v10, 10, v3
    v_lshl_add_u32 v10, v4, 4, v10
    s_lshl_b32 s40, s37, 8
    v_add_u32 v10, s40, v10
    s_lshl_b32 s51, s32, 10
    s_add_u32 s51, s51, 70656
    s_mov_b32 m0, s51
    s_movk_i32 s52, 0x2000
    s_mov_b32 s36, 0
    s_waitcnt lgkmcnt(0)
    global_load_lds_dwordx4 v10, s[4:5]
    s_mov_b32 m0, s41
    s_load_dword s35, s[30:31], 0
L_wq:
    global_load_lds_dwordx4 v8, s[8:9] nt
    s_addk_i32 m0, 1056
    s_add_u32 s36, s36, 0x20000000
    v_add_u32 v8, s52, v8
    s_cbranch_scc0 L_wq
    s_add_u32 m0, s41, 33792
    s_nop 0
L_wuk:
    global_load_lds_dwordx4 v7, s[10:11] nt
    s_addk_i32 m0, 1056
    s_add_u32 s36, s36, 0x20000000
    v_add_u32 v7, s52, v7
    s_cbranch_scc0 L_wuk
    s_branch L_w
L_at0:
    s_getpc_b64 s[58:59]
    s_lshl4_add_u32 s39, s33, s34
    s_lshl_b32 s40, s39, 17
    v_lshl_add_u32 v6, v0, 4, s40
    s_mul_i32 m0, s32, 1040
    s_lshl2_add_u32 s36, s34, s32
    s_lshl_b32 s36, s36, 9
    v_and_b32 v7, 3, v0
    v_lshl_add_u32 v7, v7, 7, s36
    v_min_u32 v7, L_codeend-L_at0-8, v7
    global_load_dword v253, v7, s[58:59]
    s_movk_i32 s52, 0x1000
    s_waitcnt lgkmcnt(0)
    s_movk_i32 s36, 2
L_dma0:
    global_load_lds_dwordx4 v6, s[6:7] nt
    s_addk_i32 m0, 4160
    v_add_u32 v6, s52, v6
    s_sub_u32 s36, s36, 1
    s_cmp_lg_u32 s36, 0
    s_cbranch_scc1 L_dma0
    s_branch L_at
L_entry_end:
L_w:
    v_mul_u32_u24 v12, 1056, v9
    v_lshl_add_u32 v12, v3, 8, v12
    v_and_b32 v11, 1, v3
    v_lshlrev_b32 v11, 1, v11
    v_xor_b32 v11, v11, v1
    v_lshl_add_u32 v12, v11, 6, v12
    v_and_b32 v11, 3, v2
    v_lshl_add_u32 v12, v11, 3, v12
    v_lshlrev_b32 v228, 8, v9
    v_lshl_add_u32 v228, v3, 4, v228
    v_add_u32 v228, s51, v228
    s_lshl_b32 s40, s38, 13
    s_add_u32 s50, s40, 69632
    v_and_b32 v8, 32, v2
    v_lshlrev_b32 v10, 5, v8
    v_lshl_add_u32 v10, v1, 8, v10
    v_and_b32 v8, 31, v2
    v_lshl_add_u32 v10, v8, 3, v10
    v_add_u32 v10, s50, v10
    s_xor_b32 s40, s40, 16384
    s_lshl_b32 s50, s37, 11
    s_add_u32 s40, s40, s50
    s_add_u32 s40, s40, 65536
    v_lshl_add_u32 v14, v0, 2, s40
    v_mul_u32_u24 v80, 2112, v11
    v_lshl_add_u32 v80, v9, 8, v80
    v_and_b32 v8, 1, v9
    v_lshlrev_b32 v8, 1, v8
    v_xor_b32 v8, v8, v3
    v_lshl_add_u32 v80, v8, 6, v80
    s_add_u32 s40, s41, 33792
    v_add_u32 v80, s40, v80
    v_bfe_u32 v81, v2, 3, 2
    v_lshlrev_b32 v81, 8, v81
    v_lshl_add_u32 v81, v1, 6, v81
    v_and_b32 v8, 32, v2
    v_add_u32 v81, v81, v8
    v_and_b32 v8, 7, v2
    v_lshl_add_u32 v81, v8, 2, v81
    v_add_u32 v81, 67584, v81
    v_lshlrev_b32 v82, 8, v9
    v_lshl_add_u32 v82, v3, 6, v82
    v_add_u32 v82, 67584, v82
    s_lshl_b32 s40, s38, 10
    s_lshl_b32 s50, s37, 8
    s_add_u32 s40, s40, s50
    s_add_u32 s40, s40, 589824
    v_lshlrev_b32 v7, 15, v3
    v_lshl_add_u32 v7, v1, 6, v7
    v_lshl_add_u32 v7, v4, 2, v7
    v_add_u32 v7, s40, v7
    s_mov_b32 s53, 0x3e0293ee
    s_mov_b32 s42, 0x05040100
    s_mov_b32 s43, 0x07060302
    v_mov_b32 v86, 0
    v_mov_b32 v87, 0
    s_lshl4_add_u32 s54, s33, s34
    s_waitcnt lgkmcnt(0)
    s_add_u32 s35, s35, 1
    s_bfe_u32 s44, s35, 0x10000
    s_bfe_u32 s50, s35, 0x10001
    s_lshl_b32 s50, s50, 16
    s_or_b32 s44, s44, s50
    s_bfe_u32 s45, s35, 0x10002
    s_bfe_u32 s50, s35, 0x10003
    s_lshl_b32 s50, s50, 16
    s_or_b32 s45, s45, s50
    s_xor_b32 s46, s45, 0x10001
    s_mov_b32 s48, 0xffffff00
    s_mov_b32 s49, 0xfffefffe
    s_and_b32 s50, s35, 0xff
    v_mov_b32 v5, s50
    v_lshlrev_b32 v8, 1, v11
    v_lshrrev_b32 v8, v8, s35
    v_and_b32 v83, 1, v8
    v_and_b32 v8, 2, v8
    v_lshl_or_b32 v83, v8, 15, v83
    v_cmp_gt_u32 vcc, 2, v11
    v_mov_b32 v85, s35
    v_mov_b32 v8, s49
    v_cndmask_b32 v83, 0, v83, vcc
    v_cndmask_b32 v224, -1, v8, vcc
    s_lshl_b32 s40, s54, 2
    s_add_u32 s40, s40, 851968
    v_mul_u32_u24 v84, 512, v2
    v_add_u32 v84, s40, v84
    v_add_u32 v225, 7798784, v10
    v_add_u32 v226, 7798784, v14
    global_load_dword v227, v226, s[30:31] sc1
    global_load_dword v227, v226, s[30:31] offset:1024 sc1
    s_waitcnt vmcnt(18)
    ds_read_b128 v[16:19], v228 offset:0
    ds_read_b128 v[20:23], v228 offset:64
    ds_read_b128 v[24:27], v228 offset:128
    ds_read_b128 v[28:31], v228 offset:192
    s_waitcnt vmcnt(10) lgkmcnt(0)
    s_barrier
    ds_read_b64_tr_b16 v[96:97], v12 offset:0
    ds_read_b64_tr_b16 v[98:99], v12 offset:4224
    ds_read_b64_tr_b16 v[112:113], v12 offset:32
    ds_read_b64_tr_b16 v[114:115], v12 offset:4256
    ds_read_b64_tr_b16 v[100:101], v12 offset:8448
    ds_read_b64_tr_b16 v[102:103], v12 offset:12672
    ds_read_b64_tr_b16 v[116:117], v12 offset:8480
    ds_read_b64_tr_b16 v[118:119], v12 offset:12704
    ds_read_b64_tr_b16 v[104:105], v12 offset:16896
    ds_read_b64_tr_b16 v[106:107], v12 offset:21120
    ds_read_b64_tr_b16 v[120:121], v12 offset:16928
    ds_read_b64_tr_b16 v[122:123], v12 offset:21152
    ds_read_b64_tr_b16 v[108:109], v12 offset:25344
    ds_read_b64_tr_b16 v[110:111], v12 offset:29568
    ds_read_b64_tr_b16 v[124:125], v12 offset:25376
    ds_read_b64_tr_b16 v[126:127], v12 offset:29600
    s_waitcnt lgkmcnt(12)
    v_mfma_f32_16x16x32_bf16 v[88:91], v[16:19], v[96:99], 0
    v_mfma_f32_16x16x32_bf16 v[92:95], v[16:19], v[112:115], 0
    s_waitcnt lgkmcnt(8)
    v_mfma_f32_16x16x32_bf16 v[88:91], v[20:23], v[100:103], v[88:91]
    v_mfma_f32_16x16x32_bf16 v[92:95], v[20:23], v[116:119], v[92:95]
    s_waitcnt lgkmcnt(4)
    v_mfma_f32_16x16x32_bf16 v[88:91], v[24:27], v[104:107], v[88:91]
    v_mfma_f32_16x16x32_bf16 v[92:95], v[24:27], v[120:123], v[92:95]
    s_waitcnt lgkmcnt(0)
    v_mfma_f32_16x16x32_bf16 v[88:91], v[28:31], v[108:111], v[88:91]
    v_mfma_f32_16x16x32_bf16 v[92:95], v[28:31], v[124:127], v[92:95]
    s_nop 6
    v_and_or_b32 v40, v88, s48, v5
    global_store_dword v226, v40, s[30:31]
    v_and_or_b32 v41, v92, s48, v5
    global_store_dword v226, v41, s[30:31] offset:1024
    s_waitcnt vmcnt(5)
    global_load_dwordx2 v[32:33], v225, s[30:31] offset:-4096 sc1
    global_load_dwordx2 v[34:35], v225, s[30:31] offset:-2048 sc1
    global_load_dwordx2 v[36:37], v225, s[30:31] offset:0 sc1
    global_load_dwordx2 v[38:39], v225, s[30:31] offset:2048 sc1
    s_waitcnt vmcnt(8)
    ds_read_b128 v[48:51], v80 offset:0
    ds_read_b128 v[52:55], v80 offset:16
    ds_read_b128 v[56:59], v80 offset:32
    ds_read_b128 v[60:63], v80 offset:48
    ds_read_b128 v[64:67], v80 offset:1056
    ds_read_b128 v[68:71], v80 offset:1072
    ds_read_b128 v[72:75], v80 offset:1088
    ds_read_b128 v[76:79], v80 offset:1104
    s_movk_i32 s51, 100
    s_branch L_qc
L_qp:
    global_load_dwordx2 v[32:33], v225, s[30:31] offset:-4096 sc1
    global_load_dwordx2 v[34:35], v225, s[30:31] offset:-2048 sc1
    global_load_dwordx2 v[36:37], v225, s[30:31] offset:0 sc1
    global_load_dwordx2 v[38:39], v225, s[30:31] offset:2048 sc1
L_qc:
    s_sub_u32 s51, s51, 1
    s_waitcnt vmcnt(0)
    v_xor_b32 v32, v32, v5
    v_xor_b32 v33, v33, v5
    v_xor_b32 v34, v34, v5
    v_xor_b32 v35, v35, v5
    v_xor_b32 v36, v36, v5
    v_xor_b32 v37, v37, v5
    v_xor_b32 v38, v38, v5
    v_xor_b32 v39, v39, v5
    v_or_b32 v15, v32, v33
    v_or3_b32 v15, v15, v34, v35
    v_or3_b32 v15, v15, v36, v37
    v_or3_b32 v15, v15, v38, v39
    v_and_b32 v15, 0xff, v15
    v_cmp_ne_u32 vcc, 0, v15
    s_cbranch_scc1 L_qs
    s_cbranch_vccnz L_qp
L_qd:
    v_pk_add_f32 v[32:33], v[32:33], v[34:35]
    v_pk_add_f32 v[36:37], v[36:37], v[38:39]
    v_pk_add_f32 v[32:33], v[32:33], v[36:37]
    v_cvt_pk_bf16_f32 v32, v32, v33
    ds_write_b32 v81, v32
    global_store_dword v14, v40, s[30:31] sc1
    global_store_dword v14, v41, s[30:31] offset:1024 sc1
    s_waitcnt lgkmcnt(0)
    s_barrier
    ds_read_b128 v[96:99], v82 offset:0
    ds_read_b128 v[100:103], v82 offset:16
    ds_read_b128 v[104:107], v82 offset:32
    ds_read_b128 v[108:111], v82 offset:48
    s_waitcnt lgkmcnt(3)
    v_mfma_f32_16x16x32_bf16 v[88:91], v[96:99], v[48:51], 0
    v_mfma_f32_16x16x32_bf16 v[92:95], v[96:99], v[64:67], 0
    s_waitcnt lgkmcnt(2)
    v_mfma_f32_16x16x32_bf16 v[88:91], v[100:103], v[52:55], v[88:91]
    v_mfma_f32_16x16x32_bf16 v[92:95], v[100:103], v[68:71], v[92:95]
    s_waitcnt lgkmcnt(1)
    v_mfma_f32_16x16x32_bf16 v[88:91], v[104:107], v[56:59], v[88:91]
    v_mfma_f32_16x16x32_bf16 v[92:95], v[104:107], v[72:75], v[92:95]
    s_waitcnt lgkmcnt(0)
    v_mfma_f32_16x16x32_bf16 v[88:91], v[108:111], v[60:63], v[88:91]
    v_mfma_f32_16x16x32_bf16 v[92:95], v[108:111], v[76:79], v[92:95]
    v_lshlrev_b32 v13, 4, v13
    v_lshl_add_u32 v13, v6, 13, v13
    s_lshl_b32 s40, s38, 17
    s_lshl_b32 s50, s37, 8
    s_add_u32 s40, s40, s50
    v_add_u32 v24, s40, v13
    v_add_u32 v25, s39, v13
    v_mul_f32 v8, s53, v88
    v_mul_f32 v11, s53, v92
    v_cvt_pk_bf16_f32 v8, v8, v11
    v_and_or_b32 v8, v8, v224, v83
    global_store_dword v7, v8, s[30:31] sc1
    v_add_u32 v101, 1507328, v10
    v_add_u32 v100, 1769472, v10
    v_xor_b32 v103, 16384, v14
    v_add_u32 v103, 1507328, v103
    v_add_u32 v102, 262144, v103
    s_waitcnt vmcnt(0)
    s_barrier
    global_load_dword v104, v102, s[30:31] sc1
    global_load_dword v104, v102, s[30:31] offset:1024 sc1
    s_lshl_b32 s40, s54, 17
    s_add_u32 s40, s40, 106496
    v_min_u32 v106, 47, v2
    v_mul_u32_u24 v8, 48, v1
    v_add_u32 v106, v106, v8
    v_lshl_add_u32 v106, v106, 7, s40
    global_load_dword v104, v106, s[6:7]
    v_add_u32 v11, 33792, v12
    v_mov_b32 v105, v12
    v_and_b32 v10, 7, v4
    v_lshl_add_u32 v10, v3, 3, v10
    v_lshl_add_u32 v10, v1, 5, v10
    v_lshlrev_b32 v10, 9, v10
    s_lshl_b32 s40, s38, 4
    s_add_u32 s40, s40, 786432
    v_add_u32 v10, s40, v10
    v_mul_u32_u24 v8, 262144, v6
    v_lshl_add_u32 v8, v4, 4, v8
    s_lshl_b32 s40, s37, 13
    s_lshl_b32 s50, s38, 8
    s_add_u32 s40, s40, s50
    s_add_u32 s40, s40, 3276800
    v_add_u32 v88, s40, v8
    v_add_u32 v89, 32768, v88
    v_add_u32 v90, 65536, v88
    v_add_u32 v91, 98304, v88
    v_add_u32 v92, 131072, v88
    v_add_u32 v93, 163840, v88
    v_add_u32 v94, 196608, v88
    v_add_u32 v95, 229376, v88
    v_lshlrev_b32 v12, 8, v1
    v_lshl_add_u32 v12, v4, 4, v12
    v_add_u32 v12, 68608, v12
    v_lshlrev_b32 v13, 8, v9
    v_lshl_add_u32 v13, v3, 4, v13
    v_add_u32 v13, 67584, v13
    s_lshl_b32 s40, s37, 5
    s_add_u32 s40, s40, s38
    s_lshl_b32 s40, s40, 11
    s_add_u32 s40, s40, 1048576
    v_lshl_add_u32 v7, v0, 2, s40
    s_lshl_b32 s50, s37, 5
    s_add_u32 s50, s50, s38
    s_sub_u32 s50, s50, s54
    s_lshl_b32 s50, s50, 2
    s_add_u32 s50, s50, 131072
    v_add_u32 v84, s50, v84
    s_mov_b64 exec, 1
    global_load_dword v104, v24, s[14:15]
    global_load_dword v104, v25, s[12:13]
    s_mov_b64 exec, -1
    s_and_b32 s40, s34, 15
    s_mul_i32 s40, s40, 512
    s_add_u32 s40, s40, 917504
    v_lshl_add_u32 v6, v2, 3, s40
    s_waitcnt vmcnt(0)
    s_add_u32 m0, s41, 0
    s_nop 0
    global_load_lds_dwordx4 v24, s[14:15] offset:0 nt
    s_waitcnt vmcnt(5)
    s_add_u32 m0, s41, 32
    s_nop 0
    global_load_lds_dwordx4 v24, s[14:15] offset:1024 nt
    s_waitcnt vmcnt(5)
    s_add_u32 m0, s41, 64
    s_nop 0
    global_load_lds_dwordx4 v24, s[14:15] offset:2048 nt
    s_waitcnt vmcnt(5)
    s_add_u32 m0, s41, 96
    s_nop 0
    global_load_lds_dwordx4 v24, s[14:15] offset:3072 nt
    s_waitcnt vmcnt(5)
    s_add_u32 m0, s41, 4224
    v_add_u32 v24, 4096, v24
    global_load_lds_dwordx4 v24, s[14:15] offset:0 nt
    s_waitcnt vmcnt(5)
    s_add_u32 m0, s41, 4256
    s_nop 0
    global_load_lds_dwordx4 v24, s[14:15] offset:1024 nt
    s_waitcnt vmcnt(5)
    s_add_u32 m0, s41, 4288
    s_nop 0
    global_load_lds_dwordx4 v24, s[14:15] offset:2048 nt
    s_waitcnt vmcnt(5)
    s_add_u32 m0, s41, 4320
    s_nop 0
    global_load_lds_dwordx4 v24, s[14:15] offset:3072 nt
    s_waitcnt vmcnt(5)
    s_add_u32 m0, s41, 33792
    s_mov_b32 s52, 131072
    global_load_lds_dwordx4 v25, s[12:13] nt
    s_add_u32 m0, s41, 34848
    v_add_u32 v25, s52, v25
    global_load_lds_dwordx4 v25, s[12:13] nt
    s_add_u32 m0, s41, 35904
    v_add_u32 v25, s52, v25
    global_load_lds_dwordx4 v25, s[12:13] nt
    s_add_u32 m0, s41, 36960
    v_add_u32 v25, s52, v25
    global_load_lds_dwordx4 v25, s[12:13] nt
    s_add_u32 m0, s41, 38016
    v_add_u32 v25, s52, v25
    global_load_lds_dwordx4 v25, s[12:13] nt
    s_add_u32 m0, s41, 39072
    v_add_u32 v25, s52, v25
    global_load_lds_dwordx4 v25, s[12:13] nt
    s_add_u32 m0, s41, 40128
    v_add_u32 v25, s52, v25
    global_load_lds_dwordx4 v25, s[12:13] nt
    s_add_u32 m0, s41, 41184
    v_add_u32 v25, s52, v25
    global_load_lds_dwordx4 v25, s[12:13] nt
    s_waitcnt vmcnt(2)
    v_lshl_add_u32 v6, v1, 7, v6
    s_mov_b64 exec, 0xffff
    global_atomic_add_x2 v[128:129], v6, v[86:87], s[30:31] sc0 sc1
    s_waitcnt vmcnt(1)
    s_barrier
    s_waitcnt vmcnt(0)
    v_xor_b32 v15, s35, v128
    v_bitop3_b32 v15, v15, v129, s35 bitop3:0xf6
    v_cmp_ne_u32 vcc, 0, v15
    s_mov_b32 s55, 1
    s_cbranch_vccz L_h2x
    s_mov_b32 s55, 0
    s_mov_b64 exec, 0xffff
    global_atomic_add_x2 v[128:129], v6, v[86:87], s[30:31] sc0 sc1
    s_mov_b64 exec, -1
    ds_read_b64_tr_b16 a[0:1], v11 offset:0
    ds_read_b64_tr_b16 a[2:3], v11 offset:4224
    ds_read_b64_tr_b16 a[4:5], v11 offset:8448
    ds_read_b64_tr_b16 a[6:7], v11 offset:12672
    ds_read_b64_tr_b16 a[8:9], v11 offset:16896
    ds_read_b64_tr_b16 a[10:11], v11 offset:21120
    ds_read_b64_tr_b16 a[12:13], v11 offset:25344
    ds_read_b64_tr_b16 a[14:15], v11 offset:29568
    ds_read_b64_tr_b16 a[16:17], v11 offset:32
    ds_read_b64_tr_b16 a[18:19], v11 offset:4256
    ds_read_b64_tr_b16 a[20:21], v11 offset:8480
    ds_read_b64_tr_b16 a[22:23], v11 offset:12704
    ds_read_b64_tr_b16 a[24:25], v11 offset:16928
    ds_read_b64_tr_b16 a[26:27], v11 offset:21152
    ds_read_b64_tr_b16 a[28:29], v11 offset:25376
    ds_read_b64_tr_b16 a[30:31], v11 offset:29600
    ds_read_b64_tr_b16 a[32:33], v105 offset:0
    ds_read_b64_tr_b16 a[34:35], v105 offset:4224
    ds_read_b64_tr_b16 a[36:37], v105 offset:8448
    ds_read_b64_tr_b16 a[38:39], v105 offset:12672
    ds_read_b64_tr_b16 a[40:41], v105 offset:16896
    ds_read_b64_tr_b16 a[42:43], v105 offset:21120
    ds_read_b64_tr_b16 a[44:45], v105 offset:25344
    ds_read_b64_tr_b16 a[46:47], v105 offset:29568
    ds_read_b64_tr_b16 a[48:49], v105 offset:32
    ds_read_b64_tr_b16 a[50:51], v105 offset:4256
    ds_read_b64_tr_b16 a[52:53], v105 offset:8480
    ds_read_b64_tr_b16 a[54:55], v105 offset:12704
    ds_read_b64_tr_b16 a[56:57], v105 offset:16928
    ds_read_b64_tr_b16 a[58:59], v105 offset:21152
    ds_read_b64_tr_b16 a[60:61], v105 offset:25376
    ds_read_b64_tr_b16 a[62:63], v105 offset:29600
    s_waitcnt lgkmcnt(0)
    s_mov_b64 exec, 0xffff
    s_mov_b32 s51, 600000
Lph2_1:
    global_atomic_add_x2 v[130:131], v6, v[86:87], s[30:31] sc0 sc1
    s_waitcnt vmcnt(1)
    v_xor_b32 v15, s35, v128
    v_bitop3_b32 v15, v15, v129, s35 bitop3:0xf6
    v_cmp_ne_u32 vcc, 0, v15
    s_cbranch_vccz Ldh2_2
    global_atomic_add_x2 v[128:129], v6, v[86:87], s[30:31] sc0 sc1
    s_waitcnt vmcnt(1)
    v_xor_b32 v15, s35, v130
    v_bitop3_b32 v15, v15, v131, s35 bitop3:0xf6
    v_cmp_ne_u32 vcc, 0, v15
    s_sub_u32 s51, s51, 1
    s_cbranch_scc1 Ldh2_2
    s_cbranch_vccnz Lph2_1
Ldh2_2:
    s_mov_b64 exec, -1
L_h2x:
    s_mov_b64 exec, -1
    global_load_dwordx4 v[16:19], v10, s[30:31] sc1
    global_load_dwordx4 v[48:51], v88, s[30:31] sc1
    global_load_dwordx4 v[52:55], v89, s[30:31] sc1
    global_load_dwordx4 v[56:59], v90, s[30:31] sc1
    global_load_dwordx4 v[60:63], v91, s[30:31] sc1
    global_load_dwordx4 v[64:67], v92, s[30:31] sc1
    global_load_dwordx4 v[68:71], v93, s[30:31] sc1
    global_load_dwordx4 v[72:75], v94, s[30:31] sc1
    global_load_dwordx4 v[76:79], v95, s[30:31] sc1
    s_cmp_eq_u32 s55, 0
    s_cbranch_scc1 L_trd
    ds_read_b64_tr_b16 a[0:1], v11 offset:0
    ds_read_b64_tr_b16 a[2:3], v11 offset:4224
    ds_read_b64_tr_b16 a[4:5], v11 offset:8448
    ds_read_b64_tr_b16 a[6:7], v11 offset:12672
    ds_read_b64_tr_b16 a[8:9], v11 offset:16896
    ds_read_b64_tr_b16 a[10:11], v11 offset:21120
    ds_read_b64_tr_b16 a[12:13], v11 offset:25344
    ds_read_b64_tr_b16 a[14:15], v11 offset:29568
    ds_read_b64_tr_b16 a[16:17], v11 offset:32
    ds_read_b64_tr_b16 a[18:19], v11 offset:4256
    ds_read_b64_tr_b16 a[20:21], v11 offset:8480
    ds_read_b64_tr_b16 a[22:23], v11 offset:12704
    ds_read_b64_tr_b16 a[24:25], v11 offset:16928
    ds_read_b64_tr_b16 a[26:27], v11 offset:21152
    ds_read_b64_tr_b16 a[28:29], v11 offset:25376
    ds_read_b64_tr_b16 a[30:31], v11 offset:29600
    ds_read_b64_tr_b16 a[32:33], v105 offset:0
    ds_read_b64_tr_b16 a[34:35], v105 offset:4224
    ds_read_b64_tr_b16 a[36:37], v105 offset:8448
    ds_read_b64_tr_b16 a[38:39], v105 offset:12672
    ds_read_b64_tr_b16 a[40:41], v105 offset:16896
    ds_read_b64_tr_b16 a[42:43], v105 offset:21120
    ds_read_b64_tr_b16 a[44:45], v105 offset:25344
    ds_read_b64_tr_b16 a[46:47], v105 offset:29568
    ds_read_b64_tr_b16 a[48:49], v105 offset:32
    ds_read_b64_tr_b16 a[50:51], v105 offset:4256
    ds_read_b64_tr_b16 a[52:53], v105 offset:8480
    ds_read_b64_tr_b16 a[54:55], v105 offset:12704
    ds_read_b64_tr_b16 a[56:57], v105 offset:16928
    ds_read_b64_tr_b16 a[58:59], v105 offset:21152
    ds_read_b64_tr_b16 a[60:61], v105 offset:25376
    ds_read_b64_tr_b16 a[62:63], v105 offset:29600
L_trd:
    s_waitcnt vmcnt(8)
    v_xor_b32 v15, s35, v18
    v_bitop3_b32 v15, v15, v19, s35 bitop3:0xf6
    v_cmp_ne_u32 vcc, 0, v15
    s_cbranch_vccnz L_stbad
L_stok:
    v_mov_b32 v20, v16
    s_nop 1
    v_max_f32_dpp v20, v20, v20 row_ror:1 row_mask:0xf bank_mask:0xf
    s_nop 1
    v_max_f32_dpp v20, v20, v20 row_ror:2 row_mask:0xf bank_mask:0xf
    s_nop 1
    v_max_f32_dpp v20, v20, v20 row_ror:4 row_mask:0xf bank_mask:0xf
    v_mov_b32 v21, v20
    s_nop 1
    v_permlane16_swap_b32 v20, v21
    s_nop 1
    v_max_f32 v20, v20, v21
    v_mov_b32 v21, v20
    s_nop 1
    v_permlane32_swap_b32 v20, v21
    s_nop 1
    v_max_f32 v20, v20, v21
    v_sub_f32 v20, v16, v20
    v_exp_f32 v20, v20
    s_nop 1
    v_mov_b32_dpp v21, v20 row_shl:1 row_mask:0xf bank_mask:0xf bound_ctrl:0
    v_mul_f32 v8, v20, v17
    v_cvt_pk_bf16_f32 v20, v20, v21
    s_nop 1
    v_add_f32_dpp v8, v8, v8 row_ror:1 row_mask:0xf bank_mask:0xf
    s_nop 1
    v_add_f32_dpp v8, v8, v8 row_ror:2 row_mask:0xf bank_mask:0xf
    s_nop 1
    v_add_f32_dpp v8, v8, v8 row_ror:4 row_mask:0xf bank_mask:0xf
    v_mov_b32_dpp v108, v20 row_newbcast:0 row_mask:0xf bank_mask:0xf
    v_mov_b32_dpp v109, v20 row_newbcast:2 row_mask:0xf bank_mask:0xf
    v_mov_b32_dpp v110, v20 row_newbcast:4 row_mask:0xf bank_mask:0xf
    v_mov_b32_dpp v111, v20 row_newbcast:6 row_mask:0xf bank_mask:0xf
    v_mov_b32 v21, v8
    s_nop 1
    v_permlane16_swap_b32 v8, v21
    s_nop 1
    v_add_f32 v8, v8, v21
    v_mov_b32 v21, v8
    s_nop 1
    v_permlane32_swap_b32 v8, v21
    s_nop 1
    v_add_f32 v8, v8, v21
    v_rcp_f32 v8, v8
    v_mov_b32 v15, 0
    s_waitcnt vmcnt(6)
    v_xor_b32 v48, s44, v48
    v_xor_b32 v49, s46, v49
    v_xor_b32 v52, s44, v52
    v_xor_b32 v53, s46, v53
    v_bitop3_b32 v15, v15, v48, v49 bitop3:0xfd
    v_bitop3_b32 v15, v15, v52, v53 bitop3:0xfd
    v_perm_b32 v16, v52, v48, s42
    v_perm_b32 v20, v52, v48, s43
    v_perm_b32 v24, v53, v49, s42
    v_perm_b32 v28, v53, v49, s43
    v_perm_b32 v32, v54, v50, s42
    v_perm_b32 v36, v54, v50, s43
    v_perm_b32 v40, v55, v51, s42
    v_perm_b32 v44, v55, v51, s43
    s_waitcnt vmcnt(4)
    v_xor_b32 v56, s44, v56
    v_xor_b32 v57, s46, v57
    v_xor_b32 v60, s44, v60
    v_xor_b32 v61, s46, v61
    v_bitop3_b32 v15, v15, v56, v57 bitop3:0xfd
    v_bitop3_b32 v15, v15, v60, v61 bitop3:0xfd
    v_perm_b32 v17, v60, v56, s42
    v_perm_b32 v21, v60, v56, s43
    v_perm_b32 v25, v61, v57, s42
    v_perm_b32 v29, v61, v57, s43
    v_perm_b32 v33, v62, v58, s42
    v_perm_b32 v37, v62, v58, s43
    v_perm_b32 v41, v63, v59, s42
    v_perm_b32 v45, v63, v59, s43
    s_waitcnt vmcnt(2)
    v_xor_b32 v64, s44, v64
    v_xor_b32 v65, s46, v65
    v_xor_b32 v68, s44, v68
    v_xor_b32 v69, s46, v69
    v_bitop3_b32 v15, v15, v64, v65 bitop3:0xfd
    v_bitop3_b32 v15, v15, v68, v69 bitop3:0xfd
    v_perm_b32 v18, v68, v64, s42
    v_perm_b32 v22, v68, v64, s43
    v_perm_b32 v26, v69, v65, s42
    v_perm_b32 v30, v69, v65, s43
    v_perm_b32 v34, v70, v66, s42
    v_perm_b32 v38, v70, v66, s43
    v_perm_b32 v42, v71, v67, s42
    v_perm_b32 v46, v71, v67, s43
    s_waitcnt vmcnt(0)
    v_xor_b32 v72, s44, v72
    v_xor_b32 v73, s46, v73
    v_xor_b32 v76, s44, v76
    v_xor_b32 v77, s46, v77
    v_bitop3_b32 v15, v15, v72, v73 bitop3:0xfd
    v_bitop3_b32 v15, v15, v76, v77 bitop3:0xfd
    v_perm_b32 v19, v76, v72, s42
    v_perm_b32 v23, v76, v72, s43
    v_perm_b32 v27, v77, v73, s42
    v_perm_b32 v31, v77, v73, s43
    v_perm_b32 v35, v78, v74, s42
    v_perm_b32 v39, v78, v74, s43
    v_perm_b32 v43, v79, v75, s42
    v_perm_b32 v47, v79, v75, s43
    v_and_b32 v15, 0x10001, v15
    v_cmp_ne_u32 vcc, 0, v15
    s_cbranch_vccnz L_latbad
L_latok:
    v_mfma_f32_16x16x32_bf16 v[48:51], v[108:111], v[16:19], 0
    v_mfma_f32_16x16x32_bf16 v[52:55], v[108:111], v[20:23], 0
    v_mfma_f32_16x16x32_bf16 v[56:59], v[108:111], v[24:27], 0
    v_mfma_f32_16x16x32_bf16 v[60:63], v[108:111], v[28:31], 0
    v_mfma_f32_16x16x32_bf16 v[64:67], v[108:111], v[32:35], 0
    v_mfma_f32_16x16x32_bf16 v[68:71], v[108:111], v[36:39], 0
    v_mfma_f32_16x16x32_bf16 v[72:75], v[108:111], v[40:43], 0
    v_mfma_f32_16x16x32_bf16 v[76:79], v[108:111], v[44:47], 0
    s_nop 0
    v_mul_f32 v112, v8, v48
    v_mul_f32 v113, v8, v52
    v_cvt_pk_bf16_f32 v120, v112, v113
    v_mul_f32 v114, v8, v56
    v_mul_f32 v115, v8, v60
    v_cvt_pk_bf16_f32 v121, v114, v115
    v_mul_f32 v116, v8, v64
    v_mul_f32 v117, v8, v68
    v_cvt_pk_bf16_f32 v122, v116, v117
    v_mul_f32 v118, v8, v72
    v_mul_f32 v119, v8, v76
    v_cvt_pk_bf16_f32 v123, v118, v119
    ds_write_b128 v12, v[120:123]
    s_waitcnt lgkmcnt(0)
    s_barrier
    ds_read_b128 v[16:19], v13 offset:1024
    ds_read_b128 v[20:23], v13 offset:1088
    ds_read_b128 v[24:27], v13 offset:1152
    ds_read_b128 v[28:31], v13 offset:1216
    s_waitcnt lgkmcnt(3)
    v_mfma_f32_16x16x32_bf16 v[48:51], v[16:19], a[0:3], 0
    v_mfma_f32_16x16x32_bf16 v[52:55], v[16:19], a[16:19], 0
    s_waitcnt lgkmcnt(2)
    v_mfma_f32_16x16x32_bf16 v[48:51], v[20:23], a[4:7], v[48:51]
    v_mfma_f32_16x16x32_bf16 v[52:55], v[20:23], a[20:23], v[52:55]
    s_waitcnt lgkmcnt(1)
    v_mfma_f32_16x16x32_bf16 v[48:51], v[24:27], a[8:11], v[48:51]
    v_mfma_f32_16x16x32_bf16 v[52:55], v[24:27], a[24:27], v[52:55]
    s_waitcnt lgkmcnt(0)
    v_mfma_f32_16x16x32_bf16 v[48:51], v[28:31], a[12:15], v[48:51]
    v_mfma_f32_16x16x32_bf16 v[52:55], v[28:31], a[28:31], v[52:55]
    s_nop 6
    v_and_or_b32 v40, v48, s48, v5
    global_store_dword v102, v40, s[30:31]
    v_and_or_b32 v41, v52, s48, v5
    global_store_dword v102, v41, s[30:31] offset:1024
    s_movk_i32 s51, 100
L_cp:
    global_load_dwordx2 v[32:33], v100, s[30:31] offset:-4096 sc1
    global_load_dwordx2 v[34:35], v100, s[30:31] offset:-2048 sc1
    global_load_dwordx2 v[36:37], v100, s[30:31] offset:0 sc1
    global_load_dwordx2 v[38:39], v100, s[30:31] offset:2048 sc1
L_cc:
    s_sub_u32 s51, s51, 1
    s_waitcnt vmcnt(0)
    v_xor_b32 v32, v32, v5
    v_xor_b32 v33, v33, v5
    v_xor_b32 v34, v34, v5
    v_xor_b32 v35, v35, v5
    v_xor_b32 v36, v36, v5
    v_xor_b32 v37, v37, v5
    v_xor_b32 v38, v38, v5
    v_xor_b32 v39, v39, v5
    v_or_b32 v15, v32, v33
    v_or3_b32 v15, v15, v34, v35
    v_or3_b32 v15, v15, v36, v37
    v_or3_b32 v15, v15, v38, v39
    v_and_b32 v15, 0xff, v15
    v_cmp_ne_u32 vcc, 0, v15
    s_cbranch_scc1 L_cs
    s_cbranch_vccnz L_cp
L_cd:
    v_pk_add_f32 v[32:33], v[32:33], v[34:35]
    v_pk_add_f32 v[36:37], v[36:37], v[38:39]
    v_pk_add_f32 v[32:33], v[32:33], v[36:37]
    v_cvt_pk_bf16_f32 v32, v32, v33
    ds_write_b32 v81, v32
    s_cmp_lg_u32 s32, 0
    s_cbranch_scc1 Lfs_3
    s_mov_b64 exec, 0xffff
    global_atomic_swap v84, v85, s[30:31] sc1
    s_mov_b64 exec, -1
Lfs_3:
    global_store_dword v103, v40, s[30:31] sc1
    global_store_dword v103, v41, s[30:31] offset:1024 sc1
    s_waitcnt lgkmcnt(0)
    s_barrier
    ds_read_b128 v[16:19], v13 offset:0
    ds_read_b128 v[20:23], v13 offset:64
    ds_read_b128 v[24:27], v13 offset:128
    ds_read_b128 v[28:31], v13 offset:192
    s_waitcnt lgkmcnt(3)
    v_mfma_f32_16x16x32_bf16 v[48:51], v[16:19], a[32:35], 0
    v_mfma_f32_16x16x32_bf16 v[52:55], v[16:19], a[48:51], 0
    s_waitcnt lgkmcnt(2)
    v_mfma_f32_16x16x32_bf16 v[48:51], v[20:23], a[36:39], v[48:51]
    v_mfma_f32_16x16x32_bf16 v[52:55], v[20:23], a[52:55], v[52:55]
    s_waitcnt lgkmcnt(1)
    v_mfma_f32_16x16x32_bf16 v[48:51], v[24:27], a[40:43], v[48:51]
    v_mfma_f32_16x16x32_bf16 v[52:55], v[24:27], a[56:59], v[52:55]
    s_waitcnt lgkmcnt(0)
    v_mfma_f32_16x16x32_bf16 v[48:51], v[28:31], a[44:47], v[48:51]
    v_mfma_f32_16x16x32_bf16 v[52:55], v[28:31], a[60:63], v[52:55]
    s_nop 6
    v_and_or_b32 v42, v48, s48, v5
    global_store_dword v7, v42, s[30:31] sc1
    v_and_or_b32 v43, v52, s48, v5
    global_store_dword v7, v43, s[30:31] offset:1024 sc1
    s_endpgm
L_cs:
    global_store_dword v103, v40, s[30:31] sc1
    global_store_dword v103, v41, s[30:31] offset:1024 sc1
    s_mov_b32 s51, 600000
Lpcs_4:
    global_load_dwordx2 v[32:33], v101, s[30:31] offset:-4096 sc1
    global_load_dwordx2 v[34:35], v101, s[30:31] offset:-2048 sc1
    global_load_dwordx2 v[36:37], v101, s[30:31] offset:0 sc1
    global_load_dwordx2 v[38:39], v101, s[30:31] offset:2048 sc1
Lccs_6:
    s_waitcnt vmcnt(0)
    v_xor_b32 v32, v32, v5
    v_xor_b32 v33, v33, v5
    v_xor_b32 v34, v34, v5
    v_xor_b32 v35, v35, v5
    v_xor_b32 v36, v36, v5
    v_xor_b32 v37, v37, v5
    v_xor_b32 v38, v38, v5
    v_xor_b32 v39, v39, v5
    v_or_b32 v15, v32, v33
    v_or3_b32 v15, v15, v34, v35
    v_or3_b32 v15, v15, v36, v37
    v_or3_b32 v15, v15, v38, v39
    v_and_b32 v15, 0xff, v15
    v_cmp_ne_u32 vcc, 0, v15
    s_sub_u32 s51, s51, 1
    s_cbranch_scc1 Ldcs_5
    s_cbranch_vccnz Lpcs_4
Ldcs_5:
    s_branch L_cd
L_qs:
    global_store_dword v14, v40, s[30:31] sc1
    global_store_dword v14, v41, s[30:31] offset:1024 sc1
    s_mov_b32 s51, 600000
Lpqs_7:
    global_load_dwordx2 v[32:33], v10, s[30:31] offset:-4096 sc1
    global_load_dwordx2 v[34:35], v10, s[30:31] offset:-2048 sc1
    global_load_dwordx2 v[36:37], v10, s[30:31] offset:0 sc1
    global_load_dwordx2 v[38:39], v10, s[30:31] offset:2048 sc1
Lcqs_9:
    s_waitcnt vmcnt(0)
    v_xor_b32 v32, v32, v5
    v_xor_b32 v33, v33, v5
    v_xor_b32 v34, v34, v5
    v_xor_b32 v35, v35, v5
    v_xor_b32 v36, v36, v5
    v_xor_b32 v37, v37, v5
    v_xor_b32 v38, v38, v5
    v_xor_b32 v39, v39, v5
    v_or_b32 v15, v32, v33
    v_or3_b32 v15, v15, v34, v35
    v_or3_b32 v15, v15, v36, v37
    v_or3_b32 v15, v15, v38, v39
    v_and_b32 v15, 0xff, v15
    v_cmp_ne_u32 vcc, 0, v15
    s_sub_u32 s51, s51, 1
    s_cbranch_scc1 Ldqs_8
    s_cbranch_vccnz Lpqs_7
Ldqs_8:
    s_branch L_qd
L_stbad:
    s_mov_b32 s51, 600000
Lpst_10:
    global_load_dwordx4 v[16:19], v10, s[30:31] sc1
Lcst_12:
    s_waitcnt vmcnt(0)
    v_xor_b32 v15, s35, v18
    v_bitop3_b32 v15, v15, v19, s35 bitop3:0xf6
    v_cmp_ne_u32 vcc, 0, v15
    s_sub_u32 s51, s51, 1
    s_cbranch_scc1 Ldst_11
    s_cbranch_vccnz Lpst_10
Ldst_11:
    s_branch L_stok
L_latbad:
    s_mov_b32 s59, 0
    v_mov_b32 v15, 0
    v_bitop3_b32 v15, v15, v48, v49 bitop3:0xfd
    v_and_b32 v15, 0x10001, v15
    v_cmp_ne_u32 vcc, 0, v15
    s_cmp_lg_u64 vcc, 0
    s_addc_u32 s59, s59, s59
    v_mov_b32 v15, 0
    v_bitop3_b32 v15, v15, v52, v53 bitop3:0xfd
    v_and_b32 v15, 0x10001, v15
    v_cmp_ne_u32 vcc, 0, v15
    s_cmp_lg_u64 vcc, 0
    s_addc_u32 s59, s59, s59
    v_mov_b32 v15, 0
    v_bitop3_b32 v15, v15, v56, v57 bitop3:0xfd
    v_and_b32 v15, 0x10001, v15
    v_cmp_ne_u32 vcc, 0, v15
    s_cmp_lg_u64 vcc, 0
    s_addc_u32 s59, s59, s59
    v_mov_b32 v15, 0
    v_bitop3_b32 v15, v15, v60, v61 bitop3:0xfd
    v_and_b32 v15, 0x10001, v15
    v_cmp_ne_u32 vcc, 0, v15
    s_cmp_lg_u64 vcc, 0
    s_addc_u32 s59, s59, s59
    v_mov_b32 v15, 0
    v_bitop3_b32 v15, v15, v64, v65 bitop3:0xfd
    v_and_b32 v15, 0x10001, v15
    v_cmp_ne_u32 vcc, 0, v15
    s_cmp_lg_u64 vcc, 0
    s_addc_u32 s59, s59, s59
    v_mov_b32 v15, 0
    v_bitop3_b32 v15, v15, v68, v69 bitop3:0xfd
    v_and_b32 v15, 0x10001, v15
    v_cmp_ne_u32 vcc, 0, v15
    s_cmp_lg_u64 vcc, 0
    s_addc_u32 s59, s59, s59
    v_mov_b32 v15, 0
    v_bitop3_b32 v15, v15, v72, v73 bitop3:0xfd
    v_and_b32 v15, 0x10001, v15
    v_cmp_ne_u32 vcc, 0, v15
    s_cmp_lg_u64 vcc, 0
    s_addc_u32 s59, s59, s59
    v_mov_b32 v15, 0
    v_bitop3_b32 v15, v15, v76, v77 bitop3:0xfd
    v_and_b32 v15, 0x10001, v15
    v_cmp_ne_u32 vcc, 0, v15
    s_cmp_lg_u64 vcc, 0
    s_addc_u32 s59, s59, s59
    s_mov_b32 s51, 600000
Lplat_13:
    s_bitcmp1_b32 s59, 7
    s_cbranch_scc0 Lk_14
    global_load_dwordx4 v[48:51], v88, s[30:31] sc1
Lk_14:
    s_bitcmp1_b32 s59, 6
    s_cbranch_scc0 Lk_15
    global_load_dwordx4 v[52:55], v89, s[30:31] sc1
Lk_15:
    s_bitcmp1_b32 s59, 5
    s_cbranch_scc0 Lk_16
    global_load_dwordx4 v[56:59], v90, s[30:31] sc1
Lk_16:
    s_bitcmp1_b32 s59, 4
    s_cbranch_scc0 Lk_17
    global_load_dwordx4 v[60:63], v91, s[30:31] sc1
Lk_17:
    s_bitcmp1_b32 s59, 3
    s_cbranch_scc0 Lk_18
    global_load_dwordx4 v[64:67], v92, s[30:31] sc1
Lk_18:
    s_bitcmp1_b32 s59, 2
    s_cbranch_scc0 Lk_19
    global_load_dwordx4 v[68:71], v93, s[30:31] sc1
Lk_19:
    s_bitcmp1_b32 s59, 1
    s_cbranch_scc0 Lk_20
    global_load_dwordx4 v[72:75], v94, s[30:31] sc1
Lk_20:
    s_bitcmp1_b32 s59, 0
    s_cbranch_scc0 Lk_21
    global_load_dwordx4 v[76:79], v95, s[30:31] sc1
Lk_21:
    s_waitcnt vmcnt(0)
    s_bitcmp1_b32 s59, 7
    s_cbranch_scc0 Lk_22
    v_xor_b32 v48, s44, v48
    v_xor_b32 v49, s46, v49
    v_mov_b32 v15, 0
    v_bitop3_b32 v15, v15, v48, v49 bitop3:0xfd
    v_and_b32 v15, 0x10001, v15
    v_cmp_ne_u32 vcc, 0, v15
    s_cbranch_vccnz Lk_22
    s_bitset0_b32 s59, 7
Lk_22:
    s_bitcmp1_b32 s59, 6
    s_cbranch_scc0 Lk_23
    v_xor_b32 v52, s44, v52
    v_xor_b32 v53, s46, v53
    v_mov_b32 v15, 0
    v_bitop3_b32 v15, v15, v52, v53 bitop3:0xfd
    v_and_b32 v15, 0x10001, v15
    v_cmp_ne_u32 vcc, 0, v15
    s_cbranch_vccnz Lk_23
    s_bitset0_b32 s59, 6
Lk_23:
    s_bitcmp1_b32 s59, 5
    s_cbranch_scc0 Lk_24
    v_xor_b32 v56, s44, v56
    v_xor_b32 v57, s46, v57
    v_mov_b32 v15, 0
    v_bitop3_b32 v15, v15, v56, v57 bitop3:0xfd
    v_and_b32 v15, 0x10001, v15
    v_cmp_ne_u32 vcc, 0, v15
    s_cbranch_vccnz Lk_24
    s_bitset0_b32 s59, 5
Lk_24:
    s_bitcmp1_b32 s59, 4
    s_cbranch_scc0 Lk_25
    v_xor_b32 v60, s44, v60
    v_xor_b32 v61, s46, v61
    v_mov_b32 v15, 0
    v_bitop3_b32 v15, v15, v60, v61 bitop3:0xfd
    v_and_b32 v15, 0x10001, v15
    v_cmp_ne_u32 vcc, 0, v15
    s_cbranch_vccnz Lk_25
    s_bitset0_b32 s59, 4
Lk_25:
    s_bitcmp1_b32 s59, 3
    s_cbranch_scc0 Lk_26
    v_xor_b32 v64, s44, v64
    v_xor_b32 v65, s46, v65
    v_mov_b32 v15, 0
    v_bitop3_b32 v15, v15, v64, v65 bitop3:0xfd
    v_and_b32 v15, 0x10001, v15
    v_cmp_ne_u32 vcc, 0, v15
    s_cbranch_vccnz Lk_26
    s_bitset0_b32 s59, 3
Lk_26:
    s_bitcmp1_b32 s59, 2
    s_cbranch_scc0 Lk_27
    v_xor_b32 v68, s44, v68
    v_xor_b32 v69, s46, v69
    v_mov_b32 v15, 0
    v_bitop3_b32 v15, v15, v68, v69 bitop3:0xfd
    v_and_b32 v15, 0x10001, v15
    v_cmp_ne_u32 vcc, 0, v15
    s_cbranch_vccnz Lk_27
    s_bitset0_b32 s59, 2
Lk_27:
    s_bitcmp1_b32 s59, 1
    s_cbranch_scc0 Lk_28
    v_xor_b32 v72, s44, v72
    v_xor_b32 v73, s46, v73
    v_mov_b32 v15, 0
    v_bitop3_b32 v15, v15, v72, v73 bitop3:0xfd
    v_and_b32 v15, 0x10001, v15
    v_cmp_ne_u32 vcc, 0, v15
    s_cbranch_vccnz Lk_28
    s_bitset0_b32 s59, 1
Lk_28:
    s_bitcmp1_b32 s59, 0
    s_cbranch_scc0 Lk_29
    v_xor_b32 v76, s44, v76
    v_xor_b32 v77, s46, v77
    v_mov_b32 v15, 0
    v_bitop3_b32 v15, v15, v76, v77 bitop3:0xfd
    v_and_b32 v15, 0x10001, v15
    v_cmp_ne_u32 vcc, 0, v15
    s_cbranch_vccnz Lk_29
    s_bitset0_b32 s59, 0
Lk_29:
    s_cmp_eq_u32 s59, 0
    s_cbranch_scc1 L_latre
    s_sub_u32 s51, s51, 1
    s_cmp_lg_u32 s51, 0
    s_cbranch_scc1 Lplat_13
    s_branch L_latre
L_latre:
    v_perm_b32 v16, v52, v48, s42
    v_perm_b32 v17, v60, v56, s42
    v_perm_b32 v18, v68, v64, s42
    v_perm_b32 v19, v76, v72, s42
    v_perm_b32 v20, v52, v48, s43
    v_perm_b32 v21, v60, v56, s43
    v_perm_b32 v22, v68, v64, s43
    v_perm_b32 v23, v76, v72, s43
    v_perm_b32 v24, v53, v49, s42
    v_perm_b32 v25, v61, v57, s42
    v_perm_b32 v26, v69, v65, s42
    v_perm_b32 v27, v77, v73, s42
    v_perm_b32 v28, v53, v49, s43
    v_perm_b32 v29, v61, v57, s43
    v_perm_b32 v30, v69, v65, s43
    v_perm_b32 v31, v77, v73, s43
    v_perm_b32 v32, v54, v50, s42
    v_perm_b32 v33, v62, v58, s42
    v_perm_b32 v34, v70, v66, s42
    v_perm_b32 v35, v78, v74, s42
    v_perm_b32 v36, v54, v50, s43
    v_perm_b32 v37, v62, v58, s43
    v_perm_b32 v38, v70, v66, s43
    v_perm_b32 v39, v78, v74, s43
    v_perm_b32 v40, v55, v51, s42
    v_perm_b32 v41, v63, v59, s42
    v_perm_b32 v42, v71, v67, s42
    v_perm_b32 v43, v79, v75, s42
    v_perm_b32 v44, v55, v51, s43
    v_perm_b32 v45, v63, v59, s43
    v_perm_b32 v46, v71, v67, s43
    v_perm_b32 v47, v79, v75, s43
    s_nop 1
    s_branch L_latok
.p2alignl 6, 0xbf800000
L_at:
    s_load_dword s35, s[30:31], 0
    s_load_dwordx8 s[20:27], s[0:1], 64
    s_mov_b32 s3, s37
    s_lshr_b32 s37, s33, 1
    s_and_b32 s54, s34, 3
    s_lshl3_add_u32 s54, s54, s33
    s_mov_b32 s55, s54
    s_cmp_ge_u32 s54, 28
    s_cselect_b32 s16, 0, 1.0
    s_cselect_b32 s40, 8, 0
    s_sub_u32 s54, s54, s40
    v_and_b32 v16, 1, v3
    v_lshlrev_b32 v17, 3, v16
    v_xor_b32 v17, v17, v4
    v_lshrrev_b32 v18, 4, v0
    v_lshlrev_b32 v18, 3, v18
    s_lshl_b32 s40, s3, 7
    v_add_u32 v18, s40, v18
    v_mul_u32_u24 v18, 3584, v18
    v_and_b32 v19, 7, v17
    v_lshl_add_u32 v18, v19, 4, v18
    s_lshl_b32 s40, s54, 7
    v_add_u32 v18, s40, v18
    v_bfe_u32 v9, v2, 2, 2
    v_lshlrev_b32 v22, 10, v9
    v_lshl_add_u32 v22, v3, 4, v22
    s_lshl_b32 s40, s3, 8
    v_add_u32 v22, s40, v22
    s_and_b32 s40, s34, 3
    s_lshl_b32 s40, s40, 10
    v_lshlrev_b32 v23, 4, v2
    v_add_u32 v24, s40, v23
    s_mul_i32 s41, s32, 8320
    s_mov_b64 s[56:57], 3584
    v_and_b32 v8, 7, v2
    v_bfe_u32 v7, v2, 3, 1
    v_lshl_add_u32 v8, v8, 1, v7
    v_lshl_add_u32 v8, v1, 5, v8
    v_mul_u32_u24 v8, 1040, v8
    v_lshl_add_u32 v8, v3, 8, v8
    v_bfe_u32 v11, v2, 2, 3
    v_lshrrev_b32 v7, 5, v2
    v_lshl_add_u32 v11, v11, 1, v7
    v_mul_u32_u24 v11, 1040, v11
    v_lshl_add_u32 v11, v1, 8, v11
    v_and_b32 v7, 3, v2
    v_lshl_add_u32 v11, v7, 3, v11
    v_add_u32 v12, 66560, v11
    v_cmp_gt_u32 vcc, 8, v17
    s_waitcnt lgkmcnt(0)
    v_mov_b32 v19, s20
    v_mov_b32 v254, s18
    v_cndmask_b32 v254, v19, v254, vcc
    v_mov_b32 v19, s21
    v_mov_b32 v255, s19
    v_cndmask_b32 v255, v19, v255, vcc
    v_add_co_u32 v254, vcc, v254, v18
    s_nop 1
    v_addc_co_u32 v255, vcc, 0, v255, vcc
    s_and_b32 s40, s34, 15
    s_mul_i32 s40, s40, 512
    s_add_u32 s40, s40, 851968
    v_lshl_add_u32 v238, v2, 3, s40
    v_mov_b32 v236, 0
    v_mov_b32 v237, 0
    s_add_u32 s35, s35, 1
    s_bfe_u32 s44, s35, 0x10000
    s_bfe_u32 s50, s35, 0x10001
    s_lshl_b32 s50, s50, 16
    s_or_b32 s44, s44, s50
    s_bfe_u32 s45, s35, 0x10002
    s_bfe_u32 s50, s35, 0x10003
    s_lshl_b32 s50, s50, 16
    s_or_b32 s45, s45, s50
    s_xor_b32 s46, s45, 0x10001
    s_mov_b32 s48, 0xffffff00
    s_mov_b32 s49, 0xfffefffe
    s_and_b32 s50, s35, 0xff
    v_mov_b32 v5, s50
    v_mul_u32_u24 v224, 1040, v9
    v_lshl_add_u32 v224, v3, 8, v224
    v_and_b32 v7, 1, v3
    v_lshlrev_b32 v7, 1, v7
    v_xor_b32 v7, v7, v1
    v_lshl_add_u32 v224, v7, 6, v224
    v_and_b32 v7, 3, v2
    v_lshl_add_u32 v224, v7, 3, v224
    v_add_u32 v224, 33280, v224
    s_lshl_b32 s40, s39, 2
    s_add_u32 s40, s40, 917504
    v_mul_u32_u24 v226, 512, v2
    v_add_u32 v226, s40, v226
    v_mov_b32 v227, s35
    s_lshl_b32 s40, s32, 2
    s_lshl_b32 s98, 15, s40
    s_mov_b32 s99, 0
    s_lshl_b32 s40, s37, 15
    s_lshl_b32 s53, s32, 13
    s_add_u32 s40, s40, s53
    s_add_u32 s40, s40, 593920
    v_lshl_add_u32 v10, v2, 4, s40
    s_mul_i32 s38, s32, 8320
    v_lshl_add_u32 v13, v2, 4, s38
    v_mul_u32_u24 v229, 1040, v4
    v_lshl_add_u32 v229, v3, 8, v229
    v_lshlrev_b32 v14, 2, v4
    v_add_u32 v14, 133120, v14
    v_lshlrev_b32 v230, 2, v2
    v_add_u32 v230, 133120, v230
    v_mov_b32 v231, 0x80000000
    v_mov_b32 v60, 0x3f803f80
    v_mov_b32 v61, v60
    v_mov_b32 v62, v60
    v_mov_b32 v63, v60
    ds_write_b32 v230, v231
    v_lshlrev_b32 v235, 4, v2
    v_add_u32 v235, 133376, v235
    v_lshl_add_u32 v239, v1, 2, v235
    v_lshlrev_b32 v232, 4, v2
    v_add_u32 v232, 135424, v232
    v_lshl_add_u32 v233, v1, 10, v232
    s_mul_i32 s40, s39, 32768
    s_add_u32 s40, s40, s53
    s_add_u32 s40, s40, 3280896
    v_lshlrev_b32 v234, 10, v3
    v_lshl_add_u32 v234, v4, 4, v234
    v_add_u32 v234, s40, v234
    s_lshl_b32 s40, s39, 9
    s_add_u32 s40, s40, 786432
    v_lshl_add_u32 v250, v2, 4, s40
    v_lshl_add_u32 v250, v1, 8, v250
    v_mov_b32 v54, s49
    v_mov_b32 v58, s35
    v_mov_b32 v59, s35
    s_lshl_b32 s40, s54, 13
    s_add_u32 s40, s40, 327680
    s_lshl_b32 s36, s3, 11
    s_add_u32 s36, s36, s40
    v_lshl_add_u32 v225, v0, 2, s36
    s_and_b32 s36, s32, 1
    s_lshl_b32 s36, s36, 10
    s_add_u32 s40, s40, s36
    s_lshr_b32 s36, s32, 1
    s_lshl_b32 s36, s36, 8
    s_add_u32 s40, s40, s36
    s_add_u32 s40, s40, 4096
    v_and_b32 v7, 31, v2
    v_lshlrev_b32 v7, 3, v7
    v_lshrrev_b32 v251, 5, v2
    v_lshl_add_u32 v251, v251, 9, v7
    v_add_u32 v251, s40, v251
    v_lshlrev_b32 v252, 13, v3
    v_lshl_add_u32 v252, v17, 4, v252
    s_lshl_b32 s40, s54, 16
    s_lshr_b32 s36, s32, 1
    s_lshl_b32 s36, s36, 15
    s_add_u32 s40, s40, s36
    s_and_b32 s36, s32, 1
    s_lshl_b32 s36, s36, 12
    s_add_u32 s40, s40, s36
    s_lshl_b32 s36, s3, 8
    s_add_u32 s40, s40, s36
    v_add_u32 v252, s40, v252
    s_and_b32 s36, s34, 3
    s_lshl_b32 s36, s36, 10
    s_lshl_b32 s40, s33, 7
    s_add_u32 s36, s36, s40
    s_lshr_b32 s40, s34, 2
    s_lshl_b32 s40, s40, 5
    s_add_u32 s36, s36, s40
    v_and_b32 v55, 3, v2
    v_lshl_add_u32 v55, v55, 3, s36
    v_lshrrev_b32 v7, 4, v2
    v_lshl_add_u32 v55, v7, 1, v55
    s_mov_b32 s58, 0xbfb8aa3b
    v_add_u32 v42, 7798784, v225
    v_add_u32 v43, 7798784, v251
    s_waitcnt vmcnt(0)
    global_load_dwordx4 v[192:195], v22, s[4:5] offset:0
    global_load_dwordx4 v[196:199], v22, s[4:5] offset:64
    global_load_dwordx4 v[200:203], v22, s[4:5] offset:128
    global_load_dwordx4 v[204:207], v22, s[4:5] offset:192
    global_load_dwordx4 v[240:243], v23, s[24:25]
    global_load_dwordx4 v[244:247], v24, s[4:5]
    s_movk_i32 s36, 18
L_dma:
    global_load_lds_dwordx4 v6, s[6:7] nt
    s_addk_i32 m0, 4160
    v_add_u32 v6, s52, v6
    s_barrier
    s_sub_u32 s36, s36, 1
    s_cmp_lg_u32 s36, 0
    s_cbranch_scc1 L_dma
    s_waitcnt vmcnt(12) lgkmcnt(0)
    s_barrier
    ds_read_b64_tr_b16 a[128:129], v11 offset:0
    ds_read_b64_tr_b16 a[130:131], v11 offset:16640
    ds_read_b64_tr_b16 a[132:133], v11 offset:32
    ds_read_b64_tr_b16 a[134:135], v11 offset:16672
    ds_read_b64_tr_b16 a[136:137], v11 offset:64
    ds_read_b64_tr_b16 a[138:139], v11 offset:16704
    ds_read_b64_tr_b16 a[140:141], v11 offset:96
    ds_read_b64_tr_b16 a[142:143], v11 offset:16736
    ds_read_b64_tr_b16 a[144:145], v11 offset:128
    ds_read_b64_tr_b16 a[146:147], v11 offset:16768
    ds_read_b64_tr_b16 a[148:149], v11 offset:160
    ds_read_b64_tr_b16 a[150:151], v11 offset:16800
    ds_read_b64_tr_b16 a[152:153], v11 offset:192
    ds_read_b64_tr_b16 a[154:155], v11 offset:16832
    ds_read_b64_tr_b16 a[156:157], v11 offset:224
    ds_read_b64_tr_b16 a[158:159], v11 offset:16864
    s_cmp_lg_u32 s32, 0
    s_cbranch_scc1 Lq_30
    ds_read_b128 a[0:3], v8 offset:0
    ds_read_b128 a[4:7], v8 offset:16
    ds_read_b128 a[8:11], v8 offset:32
    ds_read_b128 a[12:15], v8 offset:48
    ds_read_b128 a[16:19], v8 offset:64
    ds_read_b128 a[20:23], v8 offset:80
    ds_read_b128 a[24:27], v8 offset:96
    ds_read_b128 a[28:31], v8 offset:112
    ds_read_b128 a[32:35], v8 offset:128
    ds_read_b128 a[36:39], v8 offset:144
    ds_read_b128 a[40:43], v8 offset:160
    ds_read_b128 a[44:47], v8 offset:176
    ds_read_b128 a[48:51], v8 offset:192
    ds_read_b128 a[52:55], v8 offset:208
    ds_read_b128 a[56:59], v8 offset:224
    ds_read_b128 a[60:63], v8 offset:240
    ds_read_b128 a[64:67], v8 offset:16640
    ds_read_b128 a[68:71], v8 offset:16656
    ds_read_b128 a[72:75], v8 offset:16672
    ds_read_b128 a[76:79], v8 offset:16688
    ds_read_b128 a[80:83], v8 offset:16704
    ds_read_b128 a[84:87], v8 offset:16720
    ds_read_b128 a[88:91], v8 offset:16736
    ds_read_b128 a[92:95], v8 offset:16752
    ds_read_b128 a[96:99], v8 offset:16768
    ds_read_b128 a[100:103], v8 offset:16784
    ds_read_b128 a[104:107], v8 offset:16800
    ds_read_b128 a[108:111], v8 offset:16816
    ds_read_b128 a[112:115], v8 offset:16832
    ds_read_b128 a[116:119], v8 offset:16848
    ds_read_b128 a[120:123], v8 offset:16864
    ds_read_b128 a[124:127], v8 offset:16880
Lq_30:
    global_load_lds_dwordx4 v6, s[6:7] nt
    s_addk_i32 m0, 4160
    v_add_u32 v6, s52, v6
    global_load_lds_dwordx4 v6, s[6:7] nt
    s_addk_i32 m0, 4160
    v_add_u32 v6, s52, v6
    global_load_lds_dwordx4 v6, s[6:7] nt
    s_addk_i32 m0, 4160
    v_add_u32 v6, s52, v6
    global_load_lds_dwordx4 v6, s[6:7] nt
    s_addk_i32 m0, 4160
    v_add_u32 v6, s52, v6
    global_load_lds_dwordx4 v6, s[6:7] nt
    s_addk_i32 m0, 4160
    v_add_u32 v6, s52, v6
    global_load_lds_dwordx4 v6, s[6:7] nt
    s_addk_i32 m0, 4160
    v_add_u32 v6, s52, v6
    global_load_lds_dwordx4 v6, s[6:7] nt
    s_addk_i32 m0, 4160
    v_add_u32 v6, s52, v6
    global_load_lds_dwordx4 v6, s[6:7] nt
    s_addk_i32 m0, 4160
    v_add_u32 v6, s52, v6
    s_waitcnt vmcnt(12) lgkmcnt(0)
    s_barrier
    ds_read_b64_tr_b16 a[160:161], v11 offset:33280
    ds_read_b64_tr_b16 a[162:163], v11 offset:49920
    ds_read_b64_tr_b16 a[164:165], v11 offset:33312
    ds_read_b64_tr_b16 a[166:167], v11 offset:49952
    ds_read_b64_tr_b16 a[168:169], v11 offset:33344
    ds_read_b64_tr_b16 a[170:171], v11 offset:49984
    ds_read_b64_tr_b16 a[172:173], v11 offset:33376
    ds_read_b64_tr_b16 a[174:175], v11 offset:50016
    ds_read_b64_tr_b16 a[176:177], v11 offset:33408
    ds_read_b64_tr_b16 a[178:179], v11 offset:50048
    ds_read_b64_tr_b16 a[180:181], v11 offset:33440
    ds_read_b64_tr_b16 a[182:183], v11 offset:50080
    ds_read_b64_tr_b16 a[184:185], v11 offset:33472
    ds_read_b64_tr_b16 a[186:187], v11 offset:50112
    ds_read_b64_tr_b16 a[188:189], v11 offset:33504
    ds_read_b64_tr_b16 a[190:191], v11 offset:50144
    s_cmp_lg_u32 s32, 1
    s_cbranch_scc1 Lq_31
    ds_read_b128 a[0:3], v8 offset:0
    ds_read_b128 a[4:7], v8 offset:16
    ds_read_b128 a[8:11], v8 offset:32
    ds_read_b128 a[12:15], v8 offset:48
    ds_read_b128 a[16:19], v8 offset:64
    ds_read_b128 a[20:23], v8 offset:80
    ds_read_b128 a[24:27], v8 offset:96
    ds_read_b128 a[28:31], v8 offset:112
    ds_read_b128 a[32:35], v8 offset:128
    ds_read_b128 a[36:39], v8 offset:144
    ds_read_b128 a[40:43], v8 offset:160
    ds_read_b128 a[44:47], v8 offset:176
    ds_read_b128 a[48:51], v8 offset:192
    ds_read_b128 a[52:55], v8 offset:208
    ds_read_b128 a[56:59], v8 offset:224
    ds_read_b128 a[60:63], v8 offset:240
    ds_read_b128 a[64:67], v8 offset:16640
    ds_read_b128 a[68:71], v8 offset:16656
    ds_read_b128 a[72:75], v8 offset:16672
    ds_read_b128 a[76:79], v8 offset:16688
    ds_read_b128 a[80:83], v8 offset:16704
    ds_read_b128 a[84:87], v8 offset:16720
    ds_read_b128 a[88:91], v8 offset:16736
    ds_read_b128 a[92:95], v8 offset:16752
    ds_read_b128 a[96:99], v8 offset:16768
    ds_read_b128 a[100:103], v8 offset:16784
    ds_read_b128 a[104:107], v8 offset:16800
    ds_read_b128 a[108:111], v8 offset:16816
    ds_read_b128 a[112:115], v8 offset:16832
    ds_read_b128 a[116:119], v8 offset:16848
    ds_read_b128 a[120:123], v8 offset:16864
    ds_read_b128 a[124:127], v8 offset:16880
Lq_31:
    global_load_lds_dwordx4 v6, s[6:7] nt
    s_addk_i32 m0, 4160
    v_add_u32 v6, s52, v6
    global_load_lds_dwordx4 v6, s[6:7] nt
    s_addk_i32 m0, 4160
    v_add_u32 v6, s52, v6
    global_load_lds_dwordx4 v6, s[6:7] nt
    s_addk_i32 m0, 4160
    v_add_u32 v6, s52, v6
    global_load_lds_dwordx4 v6, s[6:7] nt
    s_addk_i32 m0, 4160
    v_add_u32 v6, s52, v6
    s_waitcnt vmcnt(8) lgkmcnt(0)
    s_barrier
    ds_read_b64_tr_b16 a[192:193], v12 offset:0
    ds_read_b64_tr_b16 a[194:195], v12 offset:16640
    ds_read_b64_tr_b16 a[196:197], v12 offset:32
    ds_read_b64_tr_b16 a[198:199], v12 offset:16672
    ds_read_b64_tr_b16 a[200:201], v12 offset:64
    ds_read_b64_tr_b16 a[202:203], v12 offset:16704
    ds_read_b64_tr_b16 a[204:205], v12 offset:96
    ds_read_b64_tr_b16 a[206:207], v12 offset:16736
    ds_read_b64_tr_b16 a[208:209], v12 offset:128
    ds_read_b64_tr_b16 a[210:211], v12 offset:16768
    ds_read_b64_tr_b16 a[212:213], v12 offset:160
    ds_read_b64_tr_b16 a[214:215], v12 offset:16800
    ds_read_b64_tr_b16 a[216:217], v12 offset:192
    ds_read_b64_tr_b16 a[218:219], v12 offset:16832
    ds_read_b64_tr_b16 a[220:221], v12 offset:224
    ds_read_b64_tr_b16 a[222:223], v12 offset:16864
    s_cmp_lg_u32 s32, 2
    s_cbranch_scc1 Lq_32
    ds_read_b128 a[0:3], v8 offset:0
    ds_read_b128 a[4:7], v8 offset:16
    ds_read_b128 a[8:11], v8 offset:32
    ds_read_b128 a[12:15], v8 offset:48
    ds_read_b128 a[16:19], v8 offset:64
    ds_read_b128 a[20:23], v8 offset:80
    ds_read_b128 a[24:27], v8 offset:96
    ds_read_b128 a[28:31], v8 offset:112
    ds_read_b128 a[32:35], v8 offset:128
    ds_read_b128 a[36:39], v8 offset:144
    ds_read_b128 a[40:43], v8 offset:160
    ds_read_b128 a[44:47], v8 offset:176
    ds_read_b128 a[48:51], v8 offset:192
    ds_read_b128 a[52:55], v8 offset:208
    ds_read_b128 a[56:59], v8 offset:224
    ds_read_b128 a[60:63], v8 offset:240
    ds_read_b128 a[64:67], v8 offset:16640
    ds_read_b128 a[68:71], v8 offset:16656
    ds_read_b128 a[72:75], v8 offset:16672
    ds_read_b128 a[76:79], v8 offset:16688
    ds_read_b128 a[80:83], v8 offset:16704
    ds_read_b128 a[84:87], v8 offset:16720
    ds_read_b128 a[88:91], v8 offset:16736
    ds_read_b128 a[92:95], v8 offset:16752
    ds_read_b128 a[96:99], v8 offset:16768
    ds_read_b128 a[100:103], v8 offset:16784
    ds_read_b128 a[104:107], v8 offset:16800
    ds_read_b128 a[108:111], v8 offset:16816
    ds_read_b128 a[112:115], v8 offset:16832
    ds_read_b128 a[116:119], v8 offset:16848
    ds_read_b128 a[120:123], v8 offset:16864
    ds_read_b128 a[124:127], v8 offset:16880
Lq_32:
    s_waitcnt vmcnt(1)
    global_load_dwordx4 v[64:67], v10, s[30:31] offset:-4096 sc1
    global_load_dwordx4 v[68:71], v10, s[30:31] offset:-3072 sc1
    global_load_dwordx4 v[72:75], v10, s[30:31] offset:-2048 sc1
    global_load_dwordx4 v[76:79], v10, s[30:31] offset:-1024 sc1
    global_load_dwordx4 v[80:83], v10, s[30:31] offset:0 sc1
    global_load_dwordx4 v[84:87], v10, s[30:31] offset:1024 sc1
    global_load_dwordx4 v[88:91], v10, s[30:31] offset:2048 sc1
    global_load_dwordx4 v[92:95], v10, s[30:31] offset:3072 sc1
    s_waitcnt vmcnt(8) lgkmcnt(0)
    s_barrier
    ds_read_b64_tr_b16 a[224:225], v12 offset:33280
    ds_read_b64_tr_b16 a[226:227], v12 offset:49920
    ds_read_b64_tr_b16 a[228:229], v12 offset:33312
    ds_read_b64_tr_b16 a[230:231], v12 offset:49952
    ds_read_b64_tr_b16 a[232:233], v12 offset:33344
    ds_read_b64_tr_b16 a[234:235], v12 offset:49984
    ds_read_b64_tr_b16 a[236:237], v12 offset:33376
    ds_read_b64_tr_b16 a[238:239], v12 offset:50016
    ds_read_b64_tr_b16 a[240:241], v12 offset:33408
    ds_read_b64_tr_b16 a[242:243], v12 offset:50048
    ds_read_b64_tr_b16 a[244:245], v12 offset:33440
    ds_read_b64_tr_b16 a[246:247], v12 offset:50080
    ds_read_b64_tr_b16 a[248:249], v12 offset:33472
    ds_read_b64_tr_b16 a[250:251], v12 offset:50112
    ds_read_b64_tr_b16 a[252:253], v12 offset:33504
    ds_read_b64_tr_b16 a[254:255], v12 offset:50144
    s_cmp_lg_u32 s32, 3
    s_cbranch_scc1 Lq_33
    ds_read_b128 a[0:3], v8 offset:0
    ds_read_b128 a[4:7], v8 offset:16
    ds_read_b128 a[8:11], v8 offset:32
    ds_read_b128 a[12:15], v8 offset:48
    ds_read_b128 a[16:19], v8 offset:64
    ds_read_b128 a[20:23], v8 offset:80
    ds_read_b128 a[24:27], v8 offset:96
    ds_read_b128 a[28:31], v8 offset:112
    ds_read_b128 a[32:35], v8 offset:128
    ds_read_b128 a[36:39], v8 offset:144
    ds_read_b128 a[40:43], v8 offset:160
    ds_read_b128 a[44:47], v8 offset:176
    ds_read_b128 a[48:51], v8 offset:192
    ds_read_b128 a[52:55], v8 offset:208
    ds_read_b128 a[56:59], v8 offset:224
    ds_read_b128 a[60:63], v8 offset:240
    ds_read_b128 a[64:67], v8 offset:16640
    ds_read_b128 a[68:71], v8 offset:16656
    ds_read_b128 a[72:75], v8 offset:16672
    ds_read_b128 a[76:79], v8 offset:16688
    ds_read_b128 a[80:83], v8 offset:16704
    ds_read_b128 a[84:87], v8 offset:16720
    ds_read_b128 a[88:91], v8 offset:16736
    ds_read_b128 a[92:95], v8 offset:16752
    ds_read_b128 a[96:99], v8 offset:16768
    ds_read_b128 a[100:103], v8 offset:16784
    ds_read_b128 a[104:107], v8 offset:16800
    ds_read_b128 a[108:111], v8 offset:16816
    ds_read_b128 a[112:115], v8 offset:16832
    ds_read_b128 a[116:119], v8 offset:16848
    ds_read_b128 a[120:123], v8 offset:16864
    ds_read_b128 a[124:127], v8 offset:16880
Lq_33:
    v_mov_b32 v15, 0
    s_cmp_eq_u32 s16, 0
    s_cbranch_scc1 L_nof1
    s_add_u32 m0, s41, 33280
    s_nop 0
    global_load_lds_dwordx4 v[254:255], off nt
    s_addk_i32 m0, 1040
    v_lshl_add_u64 v[254:255], v[254:255], 0, s[56:57]
    global_load_lds_dwordx4 v[254:255], off nt
    s_addk_i32 m0, 1040
    v_lshl_add_u64 v[254:255], v[254:255], 0, s[56:57]
    global_load_lds_dwordx4 v[254:255], off nt
    s_addk_i32 m0, 1040
    v_lshl_add_u64 v[254:255], v[254:255], 0, s[56:57]
    global_load_lds_dwordx4 v[254:255], off nt
    s_addk_i32 m0, 1040
    v_lshl_add_u64 v[254:255], v[254:255], 0, s[56:57]
    global_load_lds_dwordx4 v[254:255], off nt
    s_addk_i32 m0, 1040
    v_lshl_add_u64 v[254:255], v[254:255], 0, s[56:57]
    global_load_lds_dwordx4 v[254:255], off nt
    s_addk_i32 m0, 1040
    v_lshl_add_u64 v[254:255], v[254:255], 0, s[56:57]
    global_load_lds_dwordx4 v[254:255], off nt
    s_addk_i32 m0, 1040
    v_lshl_add_u64 v[254:255], v[254:255], 0, s[56:57]
    global_load_lds_dwordx4 v[254:255], off nt
L_f1d:
    s_waitcnt vmcnt(15)
    v_xor_b32 v64, s44, v64
    v_xor_b32 v65, s46, v65
    v_bitop3_b32 v15, v15, v64, v65 bitop3:0xfd
    ds_write_b128 v13, v[64:67] offset:0
    s_waitcnt vmcnt(14)
    v_xor_b32 v68, s44, v68
    v_xor_b32 v69, s46, v69
    v_bitop3_b32 v15, v15, v68, v69 bitop3:0xfd
    ds_write_b128 v13, v[68:71] offset:1040
    s_waitcnt vmcnt(13)
    v_xor_b32 v72, s44, v72
    v_xor_b32 v73, s46, v73
    v_bitop3_b32 v15, v15, v72, v73 bitop3:0xfd
    ds_write_b128 v13, v[72:75] offset:2080
    s_waitcnt vmcnt(12)
    v_xor_b32 v76, s44, v76
    v_xor_b32 v77, s46, v77
    v_bitop3_b32 v15, v15, v76, v77 bitop3:0xfd
    ds_write_b128 v13, v[76:79] offset:3120
    s_waitcnt vmcnt(11)
    v_xor_b32 v80, s44, v80
    v_xor_b32 v81, s46, v81
    v_bitop3_b32 v15, v15, v80, v81 bitop3:0xfd
    ds_write_b128 v13, v[80:83] offset:4160
    s_waitcnt vmcnt(10)
    v_xor_b32 v84, s44, v84
    v_xor_b32 v85, s46, v85
    v_bitop3_b32 v15, v15, v84, v85 bitop3:0xfd
    ds_write_b128 v13, v[84:87] offset:5200
    s_waitcnt vmcnt(9)
    v_xor_b32 v88, s44, v88
    v_xor_b32 v89, s46, v89
    v_bitop3_b32 v15, v15, v88, v89 bitop3:0xfd
    ds_write_b128 v13, v[88:91] offset:6240
    s_waitcnt vmcnt(8)
    v_xor_b32 v92, s44, v92
    v_xor_b32 v93, s46, v93
    v_bitop3_b32 v15, v15, v92, v93 bitop3:0xfd
    ds_write_b128 v13, v[92:95] offset:7280
    v_and_b32 v15, 0x10001, v15
    v_cmp_ne_u32 vcc, 0, v15
    s_cbranch_vccnz L_qabad
L_qaok:
    s_waitcnt lgkmcnt(0)
L_qk:
    s_barrier
    ds_read_b128 v[64:67], v229 offset:0
    ds_read_b128 v[68:71], v229 offset:16
    ds_read_b128 v[72:75], v229 offset:32
    ds_read_b128 v[76:79], v229 offset:48
    ds_read_b128 v[80:83], v229 offset:64
    ds_read_b128 v[84:87], v229 offset:80
    s_waitcnt lgkmcnt(5)
    v_mfma_f32_16x16x32_bf16 v[16:19], a[0:3], v[64:67], 0
    ds_read_b128 v[88:91], v229 offset:96
    v_mfma_f32_16x16x32_bf16 v[20:23], a[64:67], v[64:67], 0
    ds_read_b128 v[92:95], v229 offset:112
    s_waitcnt lgkmcnt(6)
    v_mfma_f32_16x16x32_bf16 v[16:19], a[4:7], v[68:71], v[16:19]
    ds_read_b128 v[96:99], v229 offset:128
    v_mfma_f32_16x16x32_bf16 v[20:23], a[68:71], v[68:71], v[20:23]
    ds_read_b128 v[100:103], v229 offset:144
    s_waitcnt lgkmcnt(6)
    v_mfma_f32_16x16x32_bf16 v[16:19], a[8:11], v[72:75], v[16:19]
    ds_read_b128 v[104:107], v229 offset:160
    v_mfma_f32_16x16x32_bf16 v[20:23], a[72:75], v[72:75], v[20:23]
    ds_read_b128 v[108:111], v229 offset:176
    v_mfma_f32_16x16x32_bf16 v[16:19], a[12:15], v[76:79], v[16:19]
    ds_read_b128 v[112:115], v229 offset:192
    v_mfma_f32_16x16x32_bf16 v[20:23], a[76:79], v[76:79], v[20:23]
    ds_read_b128 v[116:119], v229 offset:208
    s_waitcnt lgkmcnt(8)
    v_mfma_f32_16x16x32_bf16 v[16:19], a[16:19], v[80:83], v[16:19]
    ds_read_b128 v[120:123], v229 offset:224
    v_mfma_f32_16x16x32_bf16 v[20:23], a[80:83], v[80:83], v[20:23]
    ds_read_b128 v[124:127], v229 offset:240
    v_mfma_f32_16x16x32_bf16 v[16:19], a[20:23], v[84:87], v[16:19]
    ds_read_b128 v[128:131], v229 offset:16640
    v_mfma_f32_16x16x32_bf16 v[20:23], a[84:87], v[84:87], v[20:23]
    ds_read_b128 v[132:135], v229 offset:16656
    s_waitcnt lgkmcnt(10)
    v_mfma_f32_16x16x32_bf16 v[16:19], a[24:27], v[88:91], v[16:19]
    ds_read_b128 v[136:139], v229 offset:16672
    v_mfma_f32_16x16x32_bf16 v[20:23], a[88:91], v[88:91], v[20:23]
    ds_read_b128 v[140:143], v229 offset:16688
    v_mfma_f32_16x16x32_bf16 v[16:19], a[28:31], v[92:95], v[16:19]
    ds_read_b128 v[144:147], v229 offset:16704
    v_mfma_f32_16x16x32_bf16 v[20:23], a[92:95], v[92:95], v[20:23]
    ds_read_b128 v[148:151], v229 offset:16720
    s_waitcnt lgkmcnt(10)
    v_mfma_f32_16x16x32_bf16 v[16:19], a[32:35], v[96:99], v[16:19]
    ds_read_b128 v[152:155], v229 offset:16736
    v_mfma_f32_16x16x32_bf16 v[20:23], a[96:99], v[96:99], v[20:23]
    ds_read_b128 v[156:159], v229 offset:16752
    v_mfma_f32_16x16x32_bf16 v[16:19], a[36:39], v[100:103], v[16:19]
    ds_read_b128 v[160:163], v229 offset:16768
    v_mfma_f32_16x16x32_bf16 v[20:23], a[100:103], v[100:103], v[20:23]
    ds_read_b128 v[164:167], v229 offset:16784
    v_mfma_f32_16x16x32_bf16 v[16:19], a[40:43], v[104:107], v[16:19]
    ds_read_b128 v[168:171], v229 offset:16800
    v_mfma_f32_16x16x32_bf16 v[20:23], a[104:107], v[104:107], v[20:23]
    ds_read_b128 v[172:175], v229 offset:16816
    v_mfma_f32_16x16x32_bf16 v[16:19], a[44:47], v[108:111], v[16:19]
    ds_read_b128 v[176:179], v229 offset:16832
    v_mfma_f32_16x16x32_bf16 v[20:23], a[108:111], v[108:111], v[20:23]
    ds_read_b128 v[180:183], v229 offset:16848
    s_waitcnt lgkmcnt(14)
    v_mfma_f32_16x16x32_bf16 v[16:19], a[48:51], v[112:115], v[16:19]
    ds_read_b128 v[184:187], v229 offset:16864
    v_mfma_f32_16x16x32_bf16 v[20:23], a[112:115], v[112:115], v[20:23]
    ds_read_b128 v[188:191], v229 offset:16880
    v_mfma_f32_16x16x32_bf16 v[16:19], a[52:55], v[116:119], v[16:19]
    v_mfma_f32_16x16x32_bf16 v[20:23], a[116:119], v[116:119], v[20:23]
    v_mfma_f32_16x16x32_bf16 v[16:19], a[56:59], v[120:123], v[16:19]
    v_mfma_f32_16x16x32_bf16 v[20:23], a[120:123], v[120:123], v[20:23]
    v_mfma_f32_16x16x32_bf16 v[16:19], a[60:63], v[124:127], v[16:19]
    v_mfma_f32_16x16x32_bf16 v[20:23], a[124:127], v[124:127], v[20:23]
    s_waitcnt lgkmcnt(8)
    v_mfma_f32_16x16x32_bf16 v[24:27], a[0:3], v[128:131], 0
    v_mfma_f32_16x16x32_bf16 v[28:31], a[64:67], v[128:131], 0
    v_mfma_f32_16x16x32_bf16 v[24:27], a[4:7], v[132:135], v[24:27]
    v_mfma_f32_16x16x32_bf16 v[28:31], a[68:71], v[132:135], v[28:31]
    v_mfma_f32_16x16x32_bf16 v[24:27], a[8:11], v[136:139], v[24:27]
    v_mfma_f32_16x16x32_bf16 v[28:31], a[72:75], v[136:139], v[28:31]
    v_mfma_f32_16x16x32_bf16 v[24:27], a[12:15], v[140:143], v[24:27]
    v_max3_f32 v40, v16, v17, v18
    v_max3_f32 v41, v19, v20, v21
    v_max3_f32 v40, v40, v22, v23
    v_mfma_f32_16x16x32_bf16 v[28:31], a[76:79], v[140:143], v[28:31]
    v_max_f32 v40, v40, v41
    v_ceil_f32 v40, v40
    v_mul_f32 v41, 0x43000000, v40
    v_mfma_f32_16x16x32_bf16 v[24:27], a[16:19], v[144:147], v[24:27]
    v_sub_f32 v16, v16, v40
    v_cvt_i32_f32 v41, v41
    v_sub_f32 v17, v17, v40
    v_mfma_f32_16x16x32_bf16 v[28:31], a[80:83], v[144:147], v[28:31]
    ds_max_i32 v14, v41 offset:0
    ds_write_b32 v239, v41 offset:0
    v_sub_f32 v18, v18, v40
    v_mfma_f32_16x16x32_bf16 v[24:27], a[20:23], v[148:151], v[24:27]
    v_sub_f32 v19, v19, v40
    v_sub_f32 v20, v20, v40
    v_sub_f32 v21, v21, v40
    v_mfma_f32_16x16x32_bf16 v[28:31], a[84:87], v[148:151], v[28:31]
    v_sub_f32 v22, v22, v40
    v_sub_f32 v23, v23, v40
    v_exp_f32 v16, v16
    v_mfma_f32_16x16x32_bf16 v[24:27], a[24:27], v[152:155], v[24:27]
    v_exp_f32 v17, v17
    v_exp_f32 v18, v18
    v_mfma_f32_16x16x32_bf16 v[28:31], a[88:91], v[152:155], v[28:31]
    v_exp_f32 v19, v19
    v_exp_f32 v20, v20
    v_mfma_f32_16x16x32_bf16 v[24:27], a[28:31], v[156:159], v[24:27]
    v_exp_f32 v21, v21
    v_exp_f32 v22, v22
    v_mfma_f32_16x16x32_bf16 v[28:31], a[92:95], v[156:159], v[28:31]
    v_exp_f32 v23, v23
    v_cvt_pk_bf16_f32 v48, v16, v17
    s_waitcnt lgkmcnt(2)
    v_mfma_f32_16x16x32_bf16 v[24:27], a[32:35], v[160:163], v[24:27]
    v_cvt_pk_bf16_f32 v49, v18, v19
    v_cvt_pk_bf16_f32 v50, v20, v21
    v_mfma_f32_16x16x32_bf16 v[28:31], a[96:99], v[160:163], v[28:31]
    v_cvt_pk_bf16_f32 v51, v22, v23
    ds_write_b128 v233, v[48:51] offset:0
    v_mfma_f32_16x16x32_bf16 v[24:27], a[36:39], v[164:167], v[24:27]
    v_mfma_f32_16x16x32_bf16 v[28:31], a[100:103], v[164:167], v[28:31]
    v_mfma_f32_16x16x32_bf16 v[24:27], a[40:43], v[168:171], v[24:27]
    v_mfma_f32_16x16x32_bf16 v[28:31], a[104:107], v[168:171], v[28:31]
    v_mfma_f32_16x16x32_bf16 v[24:27], a[44:47], v[172:175], v[24:27]
    v_mfma_f32_16x16x32_bf16 v[28:31], a[108:111], v[172:175], v[28:31]
    s_waitcnt lgkmcnt(0)
    s_barrier
    ds_read_b32 v52, v14 offset:0
    v_mfma_f32_16x16x32_bf16 v[24:27], a[48:51], v[176:179], v[24:27]
    ds_read_b128 v[32:35], v235 offset:0
    ds_read_b128 v[64:67], v232 offset:0
    ds_read_b128 v[68:71], v232 offset:1024
    v_mfma_f32_16x16x32_bf16 v[28:31], a[112:115], v[176:179], v[28:31]
    ds_read_b128 v[72:75], v232 offset:2048
    ds_read_b128 v[76:79], v232 offset:3072
    v_mfma_f32_16x16x32_bf16 v[24:27], a[52:55], v[180:183], v[24:27]
    v_mfma_f32_16x16x32_bf16 v[28:31], a[116:119], v[180:183], v[28:31]
    v_mfma_f32_16x16x32_bf16 v[24:27], a[56:59], v[184:187], v[24:27]
    v_mfma_f32_16x16x32_bf16 v[28:31], a[120:123], v[184:187], v[28:31]
    s_waitcnt lgkmcnt(3)
    v_sub_u32 v32, v52, v32
    v_cvt_pk_u16_u32 v32, v32, v32
    v_mfma_f32_16x16x32_bf16 v[24:27], a[60:63], v[188:191], v[24:27]
    v_pk_sub_u16 v64, v64, v32 clamp
    v_pk_sub_u16 v65, v65, v32 clamp
    v_pk_sub_u16 v66, v66, v32 clamp
    v_mfma_f32_16x16x32_bf16 v[28:31], a[124:127], v[188:191], v[28:31]
    v_pk_sub_u16 v67, v67, v32 clamp
    s_waitcnt lgkmcnt(0)
    s_nop 0
    v_sub_u32 v33, v52, v33
    v_cvt_pk_u16_u32 v33, v33, v33
    v_pk_sub_u16 v68, v68, v33 clamp
    v_pk_sub_u16 v69, v69, v33 clamp
    v_pk_sub_u16 v70, v70, v33 clamp
    v_pk_sub_u16 v71, v71, v33 clamp
    v_mfma_f32_16x16x32_bf16 v[96:99], v[64:67], a[128:131], 0
    v_sub_u32 v34, v52, v34
    v_cvt_pk_u16_u32 v34, v34, v34
    v_pk_sub_u16 v72, v72, v34 clamp
    v_mfma_f32_16x16x32_bf16 v[100:103], v[64:67], a[132:135], 0
    v_pk_sub_u16 v73, v73, v34 clamp
    v_pk_sub_u16 v74, v74, v34 clamp
    v_pk_sub_u16 v75, v75, v34 clamp
    v_mfma_f32_16x16x32_bf16 v[104:107], v[64:67], a[136:139], 0
    v_max3_f32 v40, v24, v25, v26
    v_max3_f32 v41, v27, v28, v29
    v_max3_f32 v40, v40, v30, v31
    v_mfma_f32_16x16x32_bf16 v[108:111], v[64:67], a[140:143], 0
    v_max_f32 v40, v40, v41
    v_ceil_f32 v40, v40
    v_mul_f32 v41, 0x43000000, v40
    v_mfma_f32_16x16x32_bf16 v[112:115], v[64:67], a[144:147], 0
    v_sub_f32 v24, v24, v40
    v_cvt_i32_f32 v41, v41
    v_sub_f32 v25, v25, v40
    v_mfma_f32_16x16x32_bf16 v[116:119], v[64:67], a[148:151], 0
    ds_max_i32 v14, v41 offset:64
    ds_write_b32 v239, v41 offset:1024
    v_sub_f32 v26, v26, v40
    v_mfma_f32_16x16x32_bf16 v[120:123], v[64:67], a[152:155], 0
    v_sub_f32 v27, v27, v40
    v_sub_f32 v28, v28, v40
    v_sub_f32 v29, v29, v40
    v_mfma_f32_16x16x32_bf16 v[124:127], v[64:67], a[156:159], 0
    v_sub_f32 v30, v30, v40
    v_sub_f32 v31, v31, v40
    v_exp_f32 v24, v24
    v_mfma_f32_16x16x32_bf16 v[96:99], v[68:71], a[160:163], v[96:99]
    v_exp_f32 v25, v25
    v_exp_f32 v26, v26
    v_mfma_f32_16x16x32_bf16 v[100:103], v[68:71], a[164:167], v[100:103]
    v_exp_f32 v27, v27
    v_exp_f32 v28, v28
    v_mfma_f32_16x16x32_bf16 v[104:107], v[68:71], a[168:171], v[104:107]
    v_exp_f32 v29, v29
    v_exp_f32 v30, v30
    v_mfma_f32_16x16x32_bf16 v[108:111], v[68:71], a[172:175], v[108:111]
    v_exp_f32 v31, v31
    v_cvt_pk_bf16_f32 v48, v24, v25
    v_mfma_f32_16x16x32_bf16 v[112:115], v[68:71], a[176:179], v[112:115]
    v_cvt_pk_bf16_f32 v49, v26, v27
    v_cvt_pk_bf16_f32 v50, v28, v29
    v_cvt_pk_bf16_f32 v51, v30, v31
    v_mfma_f32_16x16x32_bf16 v[116:119], v[68:71], a[180:183], v[116:119]
    ds_write_b128 v233, v[48:51] offset:4096
    v_sub_u32 v35, v52, v35
    v_mfma_f32_16x16x32_bf16 v[120:123], v[68:71], a[184:187], v[120:123]
    v_cvt_pk_u16_u32 v35, v35, v35
    v_pk_sub_u16 v76, v76, v35 clamp
    v_mfma_f32_16x16x32_bf16 v[124:127], v[68:71], a[188:191], v[124:127]
    v_pk_sub_u16 v77, v77, v35 clamp
    v_pk_sub_u16 v78, v78, v35 clamp
    v_mfma_f32_16x16x32_bf16 v[96:99], v[72:75], a[192:195], v[96:99]
    v_pk_sub_u16 v79, v79, v35 clamp
    v_mfma_f32_16x16x32_bf16 v[100:103], v[72:75], a[196:199], v[100:103]
    v_mfma_f32_16x16x32_bf16 v[104:107], v[72:75], a[200:203], v[104:107]
    v_mfma_f32_16x16x32_bf16 v[108:111], v[72:75], a[204:207], v[108:111]
    s_waitcnt lgkmcnt(0)
    s_barrier
    ds_read_b32 v56, v14 offset:64
    v_mfma_f32_16x16x32_bf16 v[112:115], v[72:75], a[208:211], v[112:115]
    ds_read_b128 v[36:39], v235 offset:1024
    ds_read_b128 v[80:83], v232 offset:4096
    ds_read_b128 v[84:87], v232 offset:5120
    v_mfma_f32_16x16x32_bf16 v[116:119], v[72:75], a[212:215], v[116:119]
    ds_read_b128 v[88:91], v232 offset:6144
    ds_read_b128 v[92:95], v232 offset:7168
    v_mfma_f32_16x16x32_bf16 v[120:123], v[72:75], a[216:219], v[120:123]
    v_mfma_f32_16x16x32_bf16 v[124:127], v[72:75], a[220:223], v[124:127]
    v_mfma_f32_16x16x32_bf16 v[96:99], v[76:79], a[224:227], v[96:99]
    v_mfma_f32_16x16x32_bf16 v[100:103], v[76:79], a[228:231], v[100:103]
    s_waitcnt lgkmcnt(3)
    v_sub_u32 v36, v56, v36
    v_cvt_pk_u16_u32 v36, v36, v36
    v_mfma_f32_16x16x32_bf16 v[104:107], v[76:79], a[232:235], v[104:107]
    v_pk_sub_u16 v80, v80, v36 clamp
    v_pk_sub_u16 v81, v81, v36 clamp
    v_pk_sub_u16 v82, v82, v36 clamp
    v_mfma_f32_16x16x32_bf16 v[108:111], v[76:79], a[236:239], v[108:111]
    v_pk_sub_u16 v83, v83, v36 clamp
    s_waitcnt lgkmcnt(0)
    s_nop 0
    v_mfma_f32_16x16x32_bf16 v[112:115], v[76:79], a[240:243], v[112:115]
    v_mfma_f32_16x16x32_bf16 v[116:119], v[76:79], a[244:247], v[116:119]
    v_mfma_f32_16x16x32_bf16 v[120:123], v[76:79], a[248:251], v[120:123]
    v_mfma_f32_16x16x32_bf16 v[124:127], v[76:79], a[252:255], v[124:127]
    s_cmp_lg_u32 s32, 0
    s_cbranch_scc1 Lls_34
    v_mfma_f32_16x16x32_bf16 v[44:47], v[60:63], v[64:67], 0
    v_mfma_f32_16x16x32_bf16 v[44:47], v[60:63], v[68:71], v[44:47]
    v_mfma_f32_16x16x32_bf16 v[44:47], v[60:63], v[72:75], v[44:47]
    v_mfma_f32_16x16x32_bf16 v[44:47], v[60:63], v[76:79], v[44:47]
Lls_34:
    v_mfma_f32_16x16x32_bf16 v[128:131], v[80:83], a[128:131], 0
    v_sub_u32 v37, v56, v37
    v_cvt_pk_u16_u32 v37, v37, v37
    v_mfma_f32_16x16x32_bf16 v[132:135], v[80:83], a[132:135], 0
    v_pk_sub_u16 v84, v84, v37 clamp
    v_pk_sub_u16 v85, v85, v37 clamp
    v_mfma_f32_16x16x32_bf16 v[136:139], v[80:83], a[136:139], 0
    v_pk_sub_u16 v86, v86, v37 clamp
    v_pk_sub_u16 v87, v87, v37 clamp
    v_mfma_f32_16x16x32_bf16 v[140:143], v[80:83], a[140:143], 0
    v_cvt_pk_bf16_f32 v160, v96, v100
    v_cvt_pk_bf16_f32 v161, v104, v108
    v_mfma_f32_16x16x32_bf16 v[144:147], v[80:83], a[144:147], 0
    v_cvt_pk_bf16_f32 v162, v112, v116
    v_cvt_pk_bf16_f32 v163, v120, v124
    v_mfma_f32_16x16x32_bf16 v[148:151], v[80:83], a[148:151], 0
    v_and_or_b32 v160, v160, v54, s44
    v_and_or_b32 v161, v161, v54, s45
    v_mfma_f32_16x16x32_bf16 v[152:155], v[80:83], a[152:155], 0
    global_store_dwordx4 v234, v[160:163], s[30:31] offset:-4096 sc1
    v_sub_u32 v38, v56, v38
    v_mfma_f32_16x16x32_bf16 v[156:159], v[80:83], a[156:159], 0
    v_cvt_pk_u16_u32 v38, v38, v38
    v_pk_sub_u16 v88, v88, v38 clamp
    v_mfma_f32_16x16x32_bf16 v[128:131], v[84:87], a[160:163], v[128:131]
    v_pk_sub_u16 v89, v89, v38 clamp
    v_pk_sub_u16 v90, v90, v38 clamp
    v_mfma_f32_16x16x32_bf16 v[132:135], v[84:87], a[164:167], v[132:135]
    v_pk_sub_u16 v91, v91, v38 clamp
    v_cvt_pk_bf16_f32 v164, v97, v101
    v_mfma_f32_16x16x32_bf16 v[136:139], v[84:87], a[168:171], v[136:139]
    v_cvt_pk_bf16_f32 v165, v105, v109
    v_cvt_pk_bf16_f32 v166, v113, v117
    v_mfma_f32_16x16x32_bf16 v[140:143], v[84:87], a[172:175], v[140:143]
    v_cvt_pk_bf16_f32 v167, v121, v125
    v_and_or_b32 v164, v164, v54, s44
    v_mfma_f32_16x16x32_bf16 v[144:147], v[84:87], a[176:179], v[144:147]
    v_and_or_b32 v165, v165, v54, s45
    global_store_dwordx4 v234, v[164:167], s[30:31] offset:-3840 sc1
    v_mfma_f32_16x16x32_bf16 v[148:151], v[84:87], a[180:183], v[148:151]
    v_sub_u32 v39, v56, v39
    v_cvt_pk_u16_u32 v39, v39, v39
    v_mfma_f32_16x16x32_bf16 v[152:155], v[84:87], a[184:187], v[152:155]
    v_pk_sub_u16 v92, v92, v39 clamp
    v_pk_sub_u16 v93, v93, v39 clamp
    v_mfma_f32_16x16x32_bf16 v[156:159], v[84:87], a[188:191], v[156:159]
    v_pk_sub_u16 v94, v94, v39 clamp
    v_pk_sub_u16 v95, v95, v39 clamp
    v_mfma_f32_16x16x32_bf16 v[128:131], v[88:91], a[192:195], v[128:131]
    s_nop 1
    s_cmp_lg_u32 s32, 1
    s_cbranch_scc1 Lls_35
    v_mfma_f32_16x16x32_bf16 v[44:47], v[60:63], v[80:83], 0
    v_mfma_f32_16x16x32_bf16 v[44:47], v[60:63], v[84:87], v[44:47]
    v_mfma_f32_16x16x32_bf16 v[44:47], v[60:63], v[88:91], v[44:47]
    v_mfma_f32_16x16x32_bf16 v[44:47], v[60:63], v[92:95], v[44:47]
Lls_35:
    v_mfma_f32_16x16x32_bf16 v[132:135], v[88:91], a[196:199], v[132:135]
    v_cvt_pk_bf16_f32 v168, v98, v102
    v_cvt_pk_bf16_f32 v169, v106, v110
    v_mfma_f32_16x16x32_bf16 v[136:139], v[88:91], a[200:203], v[136:139]
    v_cvt_pk_bf16_f32 v170, v114, v118
    v_cvt_pk_bf16_f32 v171, v122, v126
    v_mfma_f32_16x16x32_bf16 v[140:143], v[88:91], a[204:207], v[140:143]
    v_and_or_b32 v168, v168, v54, s44
    v_and_or_b32 v169, v169, v54, s45
    v_mfma_f32_16x16x32_bf16 v[144:147], v[88:91], a[208:211], v[144:147]
    global_store_dwordx4 v234, v[168:171], s[30:31] offset:-3584 sc1
    v_cvt_pk_bf16_f32 v172, v99, v103
    v_mfma_f32_16x16x32_bf16 v[148:151], v[88:91], a[212:215], v[148:151]
    v_cvt_pk_bf16_f32 v173, v107, v111
    v_cvt_pk_bf16_f32 v174, v115, v119
    v_mfma_f32_16x16x32_bf16 v[152:155], v[88:91], a[216:219], v[152:155]
    v_cvt_pk_bf16_f32 v175, v123, v127
    v_and_or_b32 v172, v172, v54, s44
    v_mfma_f32_16x16x32_bf16 v[156:159], v[88:91], a[220:223], v[156:159]
    v_and_or_b32 v173, v173, v54, s45
    s_cmp_gt_u32 s32, 1
    s_cbranch_scc1 L_nostat
    s_cmp_eq_u32 s32, 1
    s_cselect_b64 vcc, -1, 0
    v_mov_b32 v57, v44
    s_mov_b64 exec, 0xffff
    v_cndmask_b32 v56, v52, v56, vcc
    v_cvt_f32_i32 v56, v56
    v_mul_f32 v56, 0x3c000000, v56
    global_store_dwordx4 v250, v[56:59], s[30:31] sc1
    s_mov_b64 exec, -1
L_nostat:
    v_mfma_f32_16x16x32_bf16 v[128:131], v[92:95], a[224:227], v[128:131]
    global_store_dwordx4 v234, v[172:175], s[30:31] offset:-3328 sc1
    v_mfma_f32_16x16x32_bf16 v[132:135], v[92:95], a[228:231], v[132:135]
    v_mfma_f32_16x16x32_bf16 v[136:139], v[92:95], a[232:235], v[136:139]
    v_mfma_f32_16x16x32_bf16 v[140:143], v[92:95], a[236:239], v[140:143]
    v_mfma_f32_16x16x32_bf16 v[144:147], v[92:95], a[240:243], v[144:147]
    v_mfma_f32_16x16x32_bf16 v[148:151], v[92:95], a[244:247], v[148:151]
    v_mfma_f32_16x16x32_bf16 v[152:155], v[92:95], a[248:251], v[152:155]
    v_mfma_f32_16x16x32_bf16 v[156:159], v[92:95], a[252:255], v[156:159]
    s_nop 4
    v_cvt_pk_bf16_f32 v176, v128, v132
    v_cvt_pk_bf16_f32 v177, v136, v140
    v_cvt_pk_bf16_f32 v178, v144, v148
    v_cvt_pk_bf16_f32 v179, v152, v156
    v_and_or_b32 v176, v176, v54, s44
    v_and_or_b32 v177, v177, v54, s45
    global_store_dwordx4 v234, v[176:179], s[30:31] offset:0 sc1
    v_cvt_pk_bf16_f32 v180, v129, v133
    v_cvt_pk_bf16_f32 v181, v137, v141
    v_cvt_pk_bf16_f32 v182, v145, v149
    v_cvt_pk_bf16_f32 v183, v153, v157
    v_and_or_b32 v180, v180, v54, s44
    v_and_or_b32 v181, v181, v54, s45
    global_store_dwordx4 v234, v[180:183], s[30:31] offset:256 sc1
    s_mov_b64 exec, s[98:99]
    global_atomic_swap v226, v227, s[30:31] sc1
    s_mov_b64 exec, -1
    v_cvt_pk_bf16_f32 v184, v130, v134
    v_cvt_pk_bf16_f32 v185, v138, v142
    v_cvt_pk_bf16_f32 v186, v146, v150
    v_cvt_pk_bf16_f32 v187, v154, v158
    v_and_or_b32 v184, v184, v54, s44
    v_and_or_b32 v185, v185, v54, s45
    global_store_dwordx4 v234, v[184:187], s[30:31] offset:512 sc1
    v_cvt_pk_bf16_f32 v188, v131, v135
    v_cvt_pk_bf16_f32 v189, v139, v143
    v_cvt_pk_bf16_f32 v190, v147, v151
    v_cvt_pk_bf16_f32 v191, v155, v159
    v_and_or_b32 v188, v188, v54, s44
    v_and_or_b32 v189, v189, v54, s45
    global_store_dwordx4 v234, v[188:191], s[30:31] offset:768 sc1
    v_mov_b32 v39, v55
    v_mov_b32 v228, v43
    s_cmp_eq_u32 s16, 0
    s_cbranch_scc1 L_nof2
    s_lshr_b32 s40, s41, 1
    s_add_u32 m0, s40, 66560
    s_nop 0
    global_load_lds_dwordx4 v252, s[22:23] offset:0 nt
    s_add_u32 m0, s40, 66576
    s_nop 0
    global_load_lds_dwordx4 v252, s[22:23] offset:1024 nt
    s_add_u32 m0, s40, 66592
    s_nop 0
    global_load_lds_dwordx4 v252, s[22:23] offset:2048 nt
    s_add_u32 m0, s40, 66608
    s_nop 0
    global_load_lds_dwordx4 v252, s[22:23] offset:3072 nt
    v_mov_b32 v229, v42
    s_waitcnt vmcnt(13)
    s_barrier
    ds_read_b64_tr_b16 v[64:65], v224 offset:0
    ds_read_b64_tr_b16 v[66:67], v224 offset:4160
    ds_read_b64_tr_b16 v[80:81], v224 offset:32
    ds_read_b64_tr_b16 v[82:83], v224 offset:4192
    ds_read_b64_tr_b16 v[68:69], v224 offset:8320
    ds_read_b64_tr_b16 v[70:71], v224 offset:12480
    ds_read_b64_tr_b16 v[84:85], v224 offset:8352
    ds_read_b64_tr_b16 v[86:87], v224 offset:12512
    ds_read_b64_tr_b16 v[72:73], v224 offset:16640
    ds_read_b64_tr_b16 v[74:75], v224 offset:20800
    ds_read_b64_tr_b16 v[88:89], v224 offset:16672
    ds_read_b64_tr_b16 v[90:91], v224 offset:20832
    ds_read_b64_tr_b16 v[76:77], v224 offset:24960
    ds_read_b64_tr_b16 v[78:79], v224 offset:29120
    ds_read_b64_tr_b16 v[92:93], v224 offset:24992
    ds_read_b64_tr_b16 v[94:95], v224 offset:29152
    s_waitcnt lgkmcnt(12)
    v_mfma_f32_16x16x32_bf16 v[16:19], v[192:195], v[64:67], 0
    v_mfma_f32_16x16x32_bf16 v[20:23], v[192:195], v[80:83], 0
    s_waitcnt lgkmcnt(8)
    v_mfma_f32_16x16x32_bf16 v[16:19], v[196:199], v[68:71], v[16:19]
    v_mfma_f32_16x16x32_bf16 v[20:23], v[196:199], v[84:87], v[20:23]
    s_waitcnt lgkmcnt(4)
    v_mfma_f32_16x16x32_bf16 v[16:19], v[200:203], v[72:75], v[16:19]
    v_mfma_f32_16x16x32_bf16 v[20:23], v[200:203], v[88:91], v[20:23]
    s_waitcnt lgkmcnt(0)
    v_mfma_f32_16x16x32_bf16 v[16:19], v[204:207], v[76:79], v[16:19]
    v_mfma_f32_16x16x32_bf16 v[20:23], v[204:207], v[92:95], v[20:23]
    s_nop 6
    v_and_or_b32 v24, v16, s48, v5
    global_store_dword v229, v24, s[30:31]
    v_and_or_b32 v25, v20, s48, v5
    global_store_dword v229, v25, s[30:31] offset:1024
L_nof2:
    s_bfe_u32 s52, s34, 0x10002
    s_and_b32 s53, s33, 1
    s_lshr_b32 s40, s34, 3
    s_lshl1_add_u32 s53, s53, s40
    s_and_b32 s36, s34, 3
    s_lshl2_add_u32 s40, s52, s53
    s_lshl2_add_u32 s40, s40, s36
    s_lshl_b32 s40, s40, 6
    s_lshl_b32 s57, s37, 16
    s_add_u32 s40, s40, s57
    s_add_u32 s40, s40, 1048576
    v_and_b32 v11, 3, v2
    v_lshrrev_b32 v44, 2, v2
    v_lshlrev_b32 v44, 11, v44
    v_lshl_add_u32 v44, v11, 4, v44
    v_add_u32 v44, s40, v44
    v_add_u32 v45, 32768, v44
    v_add_u32 v46, 262144, v44
    v_add_u32 v47, 262144, v45
    v_bfe_u32 v12, v2, 3, 2
    v_lshlrev_b32 v12, 7, v12
    v_lshl_add_u32 v12, v1, 5, v12
    v_and_b32 v8, 7, v2
    v_lshl_add_u32 v12, v8, 2, v12
    v_lshrrev_b32 v8, 5, v2
    v_lshl_add_u32 v12, v8, 1, v12
    v_add_u32 v12, 144128, v12
    v_lshlrev_b32 v8, 7, v9
    v_lshl_add_u32 v8, v3, 4, v8
    v_add_u32 v8, 144128, v8
    v_add_u32 v13, 33280, v224
    s_lshl_b32 s40, s3, 5
    s_add_u32 s40, s40, s55
    s_lshl_b32 s40, s40, 11
    s_add_u32 s40, s40, 1310720
    v_lshl_add_u32 v7, v0, 2, s40
    v_add_u32 v238, 131072, v238
    v_mov_b32 v48, 0
    v_mov_b32 v52, 0
    s_cmp_eq_u32 s16, 0
    s_cbranch_scc1 L_nof3
    s_movk_i32 s51, 100
L_fp:
    global_load_dwordx2 v[56:57], v228, s[30:31] offset:-4096 sc1
    global_load_dwordx2 v[58:59], v228, s[30:31] offset:-2048 sc1
    global_load_dwordx2 v[60:61], v228, s[30:31] offset:0 sc1
    global_load_dwordx2 v[62:63], v228, s[30:31] offset:2048 sc1
L_fc:
    s_sub_u32 s51, s51, 1
    s_waitcnt vmcnt(0)
    v_xor_b32 v56, v56, v5
    v_xor_b32 v57, v57, v5
    v_xor_b32 v58, v58, v5
    v_xor_b32 v59, v59, v5
    v_xor_b32 v60, v60, v5
    v_xor_b32 v61, v61, v5
    v_xor_b32 v62, v62, v5
    v_xor_b32 v63, v63, v5
    v_or_b32 v15, v56, v57
    v_or3_b32 v15, v15, v58, v59
    v_or3_b32 v15, v15, v60, v61
    v_or3_b32 v15, v15, v62, v63
    v_and_b32 v15, 0xff, v15
    v_cmp_ne_u32 vcc, 0, v15
    s_cbranch_scc1 L_fs
    s_cbranch_vccnz L_fp
L_fd:
    v_pk_add_f32 v[56:57], v[56:57], v[58:59]
    v_pk_add_f32 v[60:61], v[60:61], v[62:63]
    v_pk_add_f32 v[56:57], v[56:57], v[60:61]
    global_store_dword v225, v24, s[30:31] sc1
    global_store_dword v225, v25, s[30:31] offset:1024 sc1
    v_permlane32_swap_b32 v56, v57
    v_cvt_pk_bf16_f32 v50, v56, v56
    v_and_b32 v56, 0xffff0000, v50
    v_cvt_pk_bf16_f32 v50, v57, v57
    v_and_b32 v57, 0xffff0000, v50
    v_mul_f32 v50, s58, v56
    v_exp_f32 v50, v50
    s_nop 0
    v_add_f32 v50, 1.0, v50
    v_rcp_f32 v50, v50
    s_nop 0
    v_mul_f32 v56, v56, v50
    v_cvt_pk_bf16_f32 v50, v56, v56
    v_and_b32 v56, 0xffff0000, v50
    v_mul_f32 v56, v56, v57
    v_cvt_pk_bf16_f32 v56, v56, v56
    ds_write_b16 v12, v56
    s_waitcnt lgkmcnt(0)
    s_barrier
    ds_read_b128 v[16:19], v8 offset:0
    ds_read_b64_tr_b16 v[64:65], v13 offset:0
    ds_read_b64_tr_b16 v[66:67], v13 offset:4160
    ds_read_b64_tr_b16 v[72:73], v13 offset:32
    ds_read_b64_tr_b16 v[74:75], v13 offset:4192
    ds_read_b128 v[20:23], v8 offset:64
    ds_read_b64_tr_b16 v[68:69], v13 offset:8320
    ds_read_b64_tr_b16 v[70:71], v13 offset:12480
    ds_read_b64_tr_b16 v[76:77], v13 offset:8352
    ds_read_b64_tr_b16 v[78:79], v13 offset:12512
    s_waitcnt lgkmcnt(5)
    v_mfma_f32_16x16x32_bf16 v[48:51], v[16:19], v[64:67], 0
    v_mfma_f32_16x16x32_bf16 v[52:55], v[16:19], v[72:75], 0
    s_waitcnt lgkmcnt(0)
    v_mfma_f32_16x16x32_bf16 v[48:51], v[20:23], v[68:71], v[48:51]
    v_mfma_f32_16x16x32_bf16 v[52:55], v[20:23], v[76:79], v[52:55]
    s_nop 6
L_nof3:
    v_and_or_b32 v24, v48, s48, v5
    global_store_dword v7, v24, s[30:31] sc1
    v_and_or_b32 v25, v52, s48, v5
    global_store_dword v7, v25, s[30:31] offset:1024 sc1
    s_cmp_lg_u32 s32, 0
    s_cbranch_scc1 L_other
    s_mov_b32 exec_lo, 0x000f000f
    s_mov_b32 exec_hi, 0x000f000f
    global_store_short v39, v236, s[26:27]
    s_mov_b64 exec, -1
    s_lshl_b32 s40, s37, 7
    v_add_u32 v238, s40, v238
    s_waitcnt vmcnt(0)
    s_mov_b64 exec, 0xffff
    global_atomic_add_x2 v[56:57], v238, v[236:237], s[30:31] sc0 sc1
    s_mov_b64 exec, -1
    v_mov_b32 v248, 0
    v_lshlrev_b32 v48, 16, v240
    v_lshlrev_b32 v49, 16, v244
    v_and_b32 v50, 0xffff0000, v240
    v_and_b32 v51, 0xffff0000, v244
    v_mul_f32 v48, v48, v49
    v_mul_f32 v50, v50, v51
    v_cvt_pk_bf16_f32 v48, v48, v50
    v_lshlrev_b32 v49, 16, v48
    v_and_b32 v50, 0xffff0000, v48
    v_add_f32 v248, v248, v49
    v_add_f32 v248, v248, v50
    v_lshlrev_b32 v48, 16, v241
    v_lshlrev_b32 v49, 16, v245
    v_and_b32 v50, 0xffff0000, v241
    v_and_b32 v51, 0xffff0000, v245
    v_mul_f32 v48, v48, v49
    v_mul_f32 v50, v50, v51
    v_cvt_pk_bf16_f32 v48, v48, v50
    v_lshlrev_b32 v49, 16, v48
    v_and_b32 v50, 0xffff0000, v48
    v_add_f32 v248, v248, v49
    v_add_f32 v248, v248, v50
    v_lshlrev_b32 v48, 16, v242
    v_lshlrev_b32 v49, 16, v246
    v_and_b32 v50, 0xffff0000, v242
    v_and_b32 v51, 0xffff0000, v246
    v_mul_f32 v48, v48, v49
    v_mul_f32 v50, v50, v51
    v_cvt_pk_bf16_f32 v48, v48, v50
    v_lshlrev_b32 v49, 16, v48
    v_and_b32 v50, 0xffff0000, v48
    v_add_f32 v248, v248, v49
    v_add_f32 v248, v248, v50
    v_lshlrev_b32 v48, 16, v243
    v_lshlrev_b32 v49, 16, v247
    v_and_b32 v50, 0xffff0000, v243
    v_and_b32 v51, 0xffff0000, v247
    v_mul_f32 v48, v48, v49
    v_mul_f32 v50, v50, v51
    v_cvt_pk_bf16_f32 v48, v48, v50
    v_lshlrev_b32 v49, 16, v48
    v_and_b32 v50, 0xffff0000, v48
    v_add_f32 v248, v248, v49
    v_add_f32 v248, v248, v50
    s_nop 1
    v_add_f32_dpp v248, v248, v248 row_ror:1 row_mask:0xf bank_mask:0xf
    s_nop 1
    v_add_f32_dpp v248, v248, v248 row_ror:2 row_mask:0xf bank_mask:0xf
    s_nop 1
    v_add_f32_dpp v248, v248, v248 row_ror:4 row_mask:0xf bank_mask:0xf
    s_nop 1
    v_add_f32_dpp v248, v248, v248 row_ror:8 row_mask:0xf bank_mask:0xf
    v_mov_b32 v249, v248
    s_nop 1
    v_permlane16_swap_b32 v248, v249
    s_nop 1
    v_add_f32 v248, v248, v249
    v_mov_b32 v249, v248
    s_nop 1
    v_permlane32_swap_b32 v248, v249
    s_nop 1
    v_add_f32 v248, v248, v249
    v_cvt_pk_bf16_f32 v249, v248, v248
    v_and_b32 v248, 0xffff0000, v249
    v_mul_f32 v248, s58, v248
    v_exp_f32 v248, v248
    s_nop 0
    v_add_f32 v248, 1.0, v248
    v_rcp_f32 v248, v248
    s_nop 0
    v_cvt_pk_bf16_f32 v249, v248, v248
    v_and_b32 v248, 0xffff0000, v249
    v_sub_f32 v249, 1.0, v248
    v_cvt_pk_bf16_f32 v48, v249, v249
    v_and_b32 v249, 0xffff0000, v48
    s_mov_b64 exec, 0xffff
    s_mov_b32 s51, 600000
Lph3_36:
    global_atomic_add_x2 v[58:59], v238, v[236:237], s[30:31] sc0 sc1
    s_waitcnt vmcnt(1)
    v_xor_b32 v15, s35, v56
    v_bitop3_b32 v15, v15, v57, s35 bitop3:0xf6
    v_cmp_ne_u32 vcc, 0, v15
    s_cbranch_vccz Ldh3_37
    global_atomic_add_x2 v[56:57], v238, v[236:237], s[30:31] sc0 sc1
    s_waitcnt vmcnt(1)
    v_xor_b32 v15, s35, v58
    v_bitop3_b32 v15, v15, v59, s35 bitop3:0xf6
    v_cmp_ne_u32 vcc, 0, v15
    s_sub_u32 s51, s51, 1
    s_cbranch_scc1 Ldh3_37
    s_cbranch_vccnz Lph3_36
Ldh3_37:
    s_mov_b64 exec, -1
    s_mov_b32 s51, 600000
L_opp:
    global_load_dwordx4 v[16:19], v46, s[30:31] sc1
    global_load_dwordx4 v[20:23], v47, s[30:31] sc1
    global_load_dwordx4 v[24:27], v44, s[30:31] sc1
    global_load_dwordx4 v[28:31], v45, s[30:31] sc1
    s_waitcnt vmcnt(2)
    v_xor_b32 v16, v16, v5
    v_xor_b32 v17, v17, v5
    v_xor_b32 v18, v18, v5
    v_xor_b32 v19, v19, v5
    v_xor_b32 v20, v20, v5
    v_xor_b32 v21, v21, v5
    v_xor_b32 v22, v22, v5
    v_xor_b32 v23, v23, v5
    v_or_b32 v15, v16, v17
    v_or3_b32 v15, v15, v18, v19
    v_or3_b32 v15, v15, v20, v21
    v_or3_b32 v15, v15, v22, v23
    v_pk_add_f32 v[16:17], v[16:17], v[20:21]
    v_pk_add_f32 v[18:19], v[18:19], v[22:23]
    v_mul_f32 v16, v249, v16
    v_mul_f32 v17, v249, v17
    v_mul_f32 v18, v249, v18
    v_mul_f32 v19, v249, v19
    s_waitcnt vmcnt(1)
    v_xor_b32 v24, v24, v5
    v_xor_b32 v25, v25, v5
    v_xor_b32 v26, v26, v5
    v_xor_b32 v27, v27, v5
    v_or3_b32 v15, v15, v24, v25
    v_or3_b32 v15, v15, v26, v27
    s_waitcnt vmcnt(0)
    v_xor_b32 v28, v28, v5
    v_xor_b32 v29, v29, v5
    v_xor_b32 v30, v30, v5
    v_xor_b32 v31, v31, v5
    v_or3_b32 v15, v15, v28, v29
    v_or3_b32 v15, v15, v30, v31
    v_pk_add_f32 v[24:25], v[24:25], v[28:29]
    v_pk_add_f32 v[26:27], v[26:27], v[30:31]
    v_and_b32 v15, 0xff, v15
    v_fmac_f32 v16, v248, v24
    v_fmac_f32 v17, v248, v25
    v_fmac_f32 v18, v248, v26
    v_fmac_f32 v19, v248, v27
    v_cmp_ne_u32 vcc, 0, v15
    s_sub_u32 s51, s51, 1
    s_cbranch_scc1 L_opd
    s_cbranch_vccnz L_opp
L_opd:
    v_permlane32_swap_b32 v16, v18
    v_permlane32_swap_b32 v17, v19
    v_add_f32 v16, v16, v18
    v_add_f32 v17, v17, v19
    s_nop 1
    v_permlane16_swap_b32 v16, v17
    v_add_f32 v16, v16, v17
    s_nop 1
    v_add_f32_dpp v16, v16, v16 row_ror:4 row_mask:0xf bank_mask:0xf
    s_nop 1
    v_add_f32_dpp v16, v16, v16 row_ror:8 row_mask:0xf bank_mask:0xf
    v_cvt_pk_bf16_f32 v16, v16, v16
    s_mov_b32 exec_lo, 0x000f000f
    s_mov_b32 exec_hi, 0x000f000f
    global_store_short v39, v16, s[26:27]
L_end:
    s_endpgm
L_other:
    s_cmp_lg_u32 s32, 1
    s_cbranch_scc1 L_end
    s_cmp_lg_u32 s2, 60
    s_cbranch_scc1 L_end
    v_lshlrev_b32 v238, 3, v2
    v_add_u32 v238, 917504, v238
    s_mov_b32 s51, 600000
Lpep_38:
    global_atomic_add_x2 v[56:57], v238, v[236:237], s[30:31] sc0 sc1
Lcep_40:
    s_waitcnt vmcnt(0)
    v_xor_b32 v15, s35, v56
    v_bitop3_b32 v15, v15, v57, s35 bitop3:0xf6
    v_cmp_ne_u32 vcc, 0, v15
    s_sub_u32 s51, s51, 1
    s_cbranch_scc1 Ldep_39
    s_cbranch_vccnz Lpep_38
Ldep_39:
    s_mov_b64 exec, 1
    global_store_dword v236, v227, s[30:31] sc1
    s_endpgm
L_fs:
    global_store_dword v225, v24, s[30:31] sc1
    global_store_dword v225, v25, s[30:31] offset:1024 sc1
    s_mov_b32 s51, 600000
Lpfs_41:
    global_load_dwordx2 v[56:57], v251, s[30:31] offset:-4096 sc1
    global_load_dwordx2 v[58:59], v251, s[30:31] offset:-2048 sc1
    global_load_dwordx2 v[60:61], v251, s[30:31] offset:0 sc1
    global_load_dwordx2 v[62:63], v251, s[30:31] offset:2048 sc1
Lcfs_43:
    s_waitcnt vmcnt(0)
    v_xor_b32 v56, v56, v5
    v_xor_b32 v57, v57, v5
    v_xor_b32 v58, v58, v5
    v_xor_b32 v59, v59, v5
    v_xor_b32 v60, v60, v5
    v_xor_b32 v61, v61, v5
    v_xor_b32 v62, v62, v5
    v_xor_b32 v63, v63, v5
    v_or_b32 v15, v56, v57
    v_or3_b32 v15, v15, v58, v59
    v_or3_b32 v15, v15, v60, v61
    v_or3_b32 v15, v15, v62, v63
    v_and_b32 v15, 0xff, v15
    v_cmp_ne_u32 vcc, 0, v15
    s_sub_u32 s51, s51, 1
    s_cbranch_scc1 Ldfs_42
    s_cbranch_vccnz Lpfs_41
Ldfs_42:
    s_branch L_fd
L_nof1:
    s_waitcnt vmcnt(0)
    s_branch L_f1d
L_qabad:
    s_mov_b32 s59, 0
    v_mov_b32 v15, 0
    v_bitop3_b32 v15, v15, v64, v65 bitop3:0xfd
    v_and_b32 v15, 0x10001, v15
    v_cmp_ne_u32 vcc, 0, v15
    s_cmp_lg_u64 vcc, 0
    s_addc_u32 s59, s59, s59
    v_mov_b32 v15, 0
    v_bitop3_b32 v15, v15, v68, v69 bitop3:0xfd
    v_and_b32 v15, 0x10001, v15
    v_cmp_ne_u32 vcc, 0, v15
    s_cmp_lg_u64 vcc, 0
    s_addc_u32 s59, s59, s59
    v_mov_b32 v15, 0
    v_bitop3_b32 v15, v15, v72, v73 bitop3:0xfd
    v_and_b32 v15, 0x10001, v15
    v_cmp_ne_u32 vcc, 0, v15
    s_cmp_lg_u64 vcc, 0
    s_addc_u32 s59, s59, s59
    v_mov_b32 v15, 0
    v_bitop3_b32 v15, v15, v76, v77 bitop3:0xfd
    v_and_b32 v15, 0x10001, v15
    v_cmp_ne_u32 vcc, 0, v15
    s_cmp_lg_u64 vcc, 0
    s_addc_u32 s59, s59, s59
    v_mov_b32 v15, 0
    v_bitop3_b32 v15, v15, v80, v81 bitop3:0xfd
    v_and_b32 v15, 0x10001, v15
    v_cmp_ne_u32 vcc, 0, v15
    s_cmp_lg_u64 vcc, 0
    s_addc_u32 s59, s59, s59
    v_mov_b32 v15, 0
    v_bitop3_b32 v15, v15, v84, v85 bitop3:0xfd
    v_and_b32 v15, 0x10001, v15
    v_cmp_ne_u32 vcc, 0, v15
    s_cmp_lg_u64 vcc, 0
    s_addc_u32 s59, s59, s59
    v_mov_b32 v15, 0
    v_bitop3_b32 v15, v15, v88, v89 bitop3:0xfd
    v_and_b32 v15, 0x10001, v15
    v_cmp_ne_u32 vcc, 0, v15
    s_cmp_lg_u64 vcc, 0
    s_addc_u32 s59, s59, s59
    v_mov_b32 v15, 0
    v_bitop3_b32 v15, v15, v92, v93 bitop3:0xfd
    v_and_b32 v15, 0x10001, v15
    v_cmp_ne_u32 vcc, 0, v15
    s_cmp_lg_u64 vcc, 0
    s_addc_u32 s59, s59, s59
    s_mov_b32 s51, 600000
Lpqa_44:
    s_bitcmp1_b32 s59, 7
    s_cbranch_scc0 Lk_45
    s_waitcnt lgkmcnt(0)
    global_load_dwordx4 v[64:67], v10, s[30:31] offset:-4096 sc1
Lk_45:
    s_bitcmp1_b32 s59, 6
    s_cbranch_scc0 Lk_46
    s_waitcnt lgkmcnt(0)
    global_load_dwordx4 v[68:71], v10, s[30:31] offset:-3072 sc1
Lk_46:
    s_bitcmp1_b32 s59, 5
    s_cbranch_scc0 Lk_47
    s_waitcnt lgkmcnt(0)
    global_load_dwordx4 v[72:75], v10, s[30:31] offset:-2048 sc1
Lk_47:
    s_bitcmp1_b32 s59, 4
    s_cbranch_scc0 Lk_48
    s_waitcnt lgkmcnt(0)
    global_load_dwordx4 v[76:79], v10, s[30:31] offset:-1024 sc1
Lk_48:
    s_bitcmp1_b32 s59, 3
    s_cbranch_scc0 Lk_49
    s_waitcnt lgkmcnt(0)
    global_load_dwordx4 v[80:83], v10, s[30:31] offset:0 sc1
Lk_49:
    s_bitcmp1_b32 s59, 2
    s_cbranch_scc0 Lk_50
    s_waitcnt lgkmcnt(0)
    global_load_dwordx4 v[84:87], v10, s[30:31] offset:1024 sc1
Lk_50:
    s_bitcmp1_b32 s59, 1
    s_cbranch_scc0 Lk_51
    s_waitcnt lgkmcnt(0)
    global_load_dwordx4 v[88:91], v10, s[30:31] offset:2048 sc1
Lk_51:
    s_bitcmp1_b32 s59, 0
    s_cbranch_scc0 Lk_52
    s_waitcnt lgkmcnt(0)
    global_load_dwordx4 v[92:95], v10, s[30:31] offset:3072 sc1
Lk_52:
    s_waitcnt vmcnt(0)
    s_bitcmp1_b32 s59, 7
    s_cbranch_scc0 Lk_53
    v_xor_b32 v64, s44, v64
    v_xor_b32 v65, s46, v65
    v_mov_b32 v15, 0
    v_bitop3_b32 v15, v15, v64, v65 bitop3:0xfd
    v_and_b32 v15, 0x10001, v15
    ds_write_b128 v13, v[64:67] offset:0
    v_cmp_ne_u32 vcc, 0, v15
    s_cbranch_vccnz Lk_53
    s_bitset0_b32 s59, 7
Lk_53:
    s_bitcmp1_b32 s59, 6
    s_cbranch_scc0 Lk_54
    v_xor_b32 v68, s44, v68
    v_xor_b32 v69, s46, v69
    v_mov_b32 v15, 0
    v_bitop3_b32 v15, v15, v68, v69 bitop3:0xfd
    v_and_b32 v15, 0x10001, v15
    ds_write_b128 v13, v[68:71] offset:1040
    v_cmp_ne_u32 vcc, 0, v15
    s_cbranch_vccnz Lk_54
    s_bitset0_b32 s59, 6
Lk_54:
    s_bitcmp1_b32 s59, 5
    s_cbranch_scc0 Lk_55
    v_xor_b32 v72, s44, v72
    v_xor_b32 v73, s46, v73
    v_mov_b32 v15, 0
    v_bitop3_b32 v15, v15, v72, v73 bitop3:0xfd
    v_and_b32 v15, 0x10001, v15
    ds_write_b128 v13, v[72:75] offset:2080
    v_cmp_ne_u32 vcc, 0, v15
    s_cbranch_vccnz Lk_55
    s_bitset0_b32 s59, 5
Lk_55:
    s_bitcmp1_b32 s59, 4
    s_cbranch_scc0 Lk_56
    v_xor_b32 v76, s44, v76
    v_xor_b32 v77, s46, v77
    v_mov_b32 v15, 0
    v_bitop3_b32 v15, v15, v76, v77 bitop3:0xfd
    v_and_b32 v15, 0x10001, v15
    ds_write_b128 v13, v[76:79] offset:3120
    v_cmp_ne_u32 vcc, 0, v15
    s_cbranch_vccnz Lk_56
    s_bitset0_b32 s59, 4
Lk_56:
    s_bitcmp1_b32 s59, 3
    s_cbranch_scc0 Lk_57
    v_xor_b32 v80, s44, v80
    v_xor_b32 v81, s46, v81
    v_mov_b32 v15, 0
    v_bitop3_b32 v15, v15, v80, v81 bitop3:0xfd
    v_and_b32 v15, 0x10001, v15
    ds_write_b128 v13, v[80:83] offset:4160
    v_cmp_ne_u32 vcc, 0, v15
    s_cbranch_vccnz Lk_57
    s_bitset0_b32 s59, 3
Lk_57:
    s_bitcmp1_b32 s59, 2
    s_cbranch_scc0 Lk_58
    v_xor_b32 v84, s44, v84
    v_xor_b32 v85, s46, v85
    v_mov_b32 v15, 0
    v_bitop3_b32 v15, v15, v84, v85 bitop3:0xfd
    v_and_b32 v15, 0x10001, v15
    ds_write_b128 v13, v[84:87] offset:5200
    v_cmp_ne_u32 vcc, 0, v15
    s_cbranch_vccnz Lk_58
    s_bitset0_b32 s59, 2
Lk_58:
    s_bitcmp1_b32 s59, 1
    s_cbranch_scc0 Lk_59
    v_xor_b32 v88, s44, v88
    v_xor_b32 v89, s46, v89
    v_mov_b32 v15, 0
    v_bitop3_b32 v15, v15, v88, v89 bitop3:0xfd
    v_and_b32 v15, 0x10001, v15
    ds_write_b128 v13, v[88:91] offset:6240
    v_cmp_ne_u32 vcc, 0, v15
    s_cbranch_vccnz Lk_59
    s_bitset0_b32 s59, 1
Lk_59:
    s_bitcmp1_b32 s59, 0
    s_cbranch_scc0 Lk_60
    v_xor_b32 v92, s44, v92
    v_xor_b32 v93, s46, v93
    v_mov_b32 v15, 0
    v_bitop3_b32 v15, v15, v92, v93 bitop3:0xfd
    v_and_b32 v15, 0x10001, v15
    ds_write_b128 v13, v[92:95] offset:7280
    v_cmp_ne_u32 vcc, 0, v15
    s_cbranch_vccnz Lk_60
    s_bitset0_b32 s59, 0
Lk_60:
    s_cmp_eq_u32 s59, 0
    s_cbranch_scc1 L_qaok
    s_sub_u32 s51, s51, 1
    s_cmp_lg_u32 s51, 0
    s_cbranch_scc1 Lpqa_44
    s_branch L_qaok
L_codeend:
.section .rodata,"a"
.p2align 6
.amdhsa_kernel gated_mix__compressed_kv_cla__swiglu_ffn__decode_kernel
  .amdhsa_next_free_vgpr 512
  .amdhsa_next_free_sgpr 100
  .amdhsa_accum_offset 256
  .amdhsa_group_segment_fixed_size 0
  .amdhsa_kernarg_size 112
  .amdhsa_user_sgpr_count 2
  .amdhsa_user_sgpr_kernarg_segment_ptr 1
  .amdhsa_system_sgpr_workgroup_id_x 1
  .amdhsa_float_denorm_mode_32 3
.end_amdhsa_kernel
```
